```python
import torch

def _softmax(x, axis=-1):
    return torch.softmax(x, dim=axis)
def _gelu(x):
    return torch.nn.functional.gelu(x, approximate="tanh")
def _silu(x):
    return torch.nn.functional.silu(x)
def _sigmoid(x):
    return torch.sigmoid(x)
def _layernorm(x, axis=-1, eps=1e-5):
    m = x.mean(dim=axis, keepdim=True)
    v = x.var(dim=axis, keepdim=True, unbiased=False)
    return (x - m) / torch.sqrt(v + eps)
def _scatter_add(tgt, idx, src, axis=0):
    return tgt.clone().index_add_(axis, idx, src)
def _segment_sum(src, seg, n):
    out = torch.zeros((n,) + src.shape[1:], dtype=src.dtype)
    return out.index_add_(0, seg, src)
def _pad(x, pw):
    flat = tuple(v for pair in reversed(pw) for v in pair)
    return torch.nn.functional.pad(x, flat)

kernel_name = 'gated_mix__sliding_block_cached__geglu_ffn__decode'

def setup_inputs():

    _w = (lambda a: (lambda t: t.to(torch.bfloat16) if t.is_floating_point() else t)(torch.as_tensor(a)))
    def _A_setup():
        B, Sq, D = 8, 1, 640
        Hq, Hkv, Sk, Dh = 32, 32, 4096, 192
        assert Hq % Hkv == 0, (Hq, Hkv)
        return {
            "x": _w((lambda *s: torch.randn(*s, dtype=torch.bfloat16) * 0.05)(B, Sq, D)),
            "k_cache": _w((lambda *s: torch.randn(*s, dtype=torch.bfloat16) * 6.4)(B, Hkv, Sk, Dh)),
            "v_cache": _w((lambda *s: torch.randn(*s, dtype=torch.bfloat16) * 0.2)(B, Hkv, Sk, Dh)),
            "wq": _w((lambda *s: torch.randn(*s, dtype=torch.bfloat16) * 6.4)(D, Hq * Dh) * (D ** -0.5)),
            "wo": _w((lambda *s: torch.randn(*s, dtype=torch.bfloat16) * 0.2)(Hq * Dh, D) * ((Hq * Dh) ** -0.5)),
        }
    _A_in = _A_setup()

    def _B_setup():
        B, S, D, F = 8, 1, 640, 1536
        return {
            "x": _w((lambda *s: torch.randn(*s, dtype=torch.bfloat16) * 0.05)(B, S, D)),
            "w_gate": _w((lambda *s: torch.randn(*s, dtype=torch.bfloat16) * 0.05)(D, F)),
            "w_up": _w((lambda *s: torch.randn(*s, dtype=torch.bfloat16) * 0.05)(D, F)),
            "w_down": _w((lambda *s: torch.randn(*s, dtype=torch.bfloat16) * 0.05)(F, D)),
        }
    _B_in = _B_setup()

    return {
        "A_x": _A_in["x"],
        "A_k_cache": _A_in["k_cache"],
        "A_v_cache": _A_in["v_cache"],
        "A_wq": _A_in["wq"],
        "A_wo": _A_in["wo"],
        "B_x": _B_in["x"],
        "B_w_gate": _B_in["w_gate"],
        "B_w_up": _B_in["w_up"],
        "B_w_down": _B_in["w_down"],
        "gate_w": _w((lambda *s: torch.randn(*s, dtype=torch.bfloat16) * 0.05)(640) * 16.0),
    }

def reference(A_x, A_k_cache, A_v_cache, A_wq, A_wo, B_x, B_w_gate, B_w_up, B_w_down, gate_w):
    def _A_ref(x, k_cache, v_cache, wq, wo):
        B, Sq, D = x.shape
        Hq, Dh = 32, 192
        Hkv, Sk = k_cache.shape[1], k_cache.shape[2]
        W = min(4096, max(256, Sk // 4))
        rep = Hq // Hkv
        q = (lambda x, *d: x.permute(*d))((x @ wq).reshape(B, Sq, Hq, Dh), 0, 2, 1, 3)
        k = (lambda x, n, axis: torch.repeat_interleave(x, n, dim=axis))(k_cache[:, :, Sk - W:, :], rep, axis=1)
        v = (lambda x, n, axis: torch.repeat_interleave(x, n, dim=axis))(v_cache[:, :, Sk - W:, :], rep, axis=1)
        scores = torch.einsum("bhqd,bhkd->bhqk", q, k) * (Dh ** -0.5)
        p = _softmax(scores, axis=-1)
        o = torch.einsum("bhqk,bhkd->bhqd", p, v)
        return (lambda x, *d: x.permute(*d))(o, 0, 2, 1, 3).reshape(B, Sq, Hq * Dh) @ wo

    def _B_ref(x, w_gate, w_up, w_down):
        return (_gelu(x @ w_gate) * (x @ w_up)) @ w_down

    x = A_x
    g = _sigmoid((x * gate_w).sum(-1, keepdims=True))
    a = _A_ref(x, A_k_cache, A_v_cache, A_wq, A_wo)
    b = _B_ref(x, B_w_gate, B_w_up, B_w_down)
    return g * a + (1 - g) * b
```

```asm
; @launch kernel=gated_mix__sliding_block_cached__geglu_ffn__decode_kernel grid=(256,1,1) block=(1024,1,1) lds=139264
; @launch kernel=mixb_kernel grid=(20,1,1) block=(256,1,1) lds=0
.amdgcn_target "amdgcn-amd-amdhsa--gfx950"
.text
.globl gated_mix__sliding_block_cached__geglu_ffn__decode_kernel
.p2align 8
.type gated_mix__sliding_block_cached__geglu_ffn__decode_kernel,@function
gated_mix__sliding_block_cached__geglu_ffn__decode_kernel:
  s_cmp_ge_u32 s2, 256
  s_cbranch_scc1 L_a_end
  s_load_dwordx4 s[4:7], s[0:1], 0
  s_load_dwordx4 s[8:11], s[0:1], 16
  s_load_dwordx4 s[12:15], s[0:1], 32
  s_load_dwordx4 s[16:19], s[0:1], 48
  s_load_dwordx2 s[20:21], s[0:1], 64
  s_load_dwordx2 s[22:23], s[0:1], 96
  v_lshrrev_b32 v1, 6, v0
  v_and_b32 v0, 63, v0
  v_readfirstlane_b32 s60, v1
  s_lshr_b32 s61, s2, 5
  s_and_b32 s62, s2, 7
  s_lshl_b32 s62, s62, 2
  s_bfe_u32 s63, s2, 0x20003
  s_add_u32 s62, s62, s63
  s_lshl_b32 s63, s61, 5
  s_add_u32 s2, s63, s62
  s_mov_b32 s85, 0x05040100
  s_mov_b32 s86, 0x07060302
  s_mov_b32 s87, 0x3d93cd3a
  s_mov_b32 s88, 0x3fb8aa3b
  s_mov_b32 s91, 3072
  s_mov_b32 s92, 6144
  s_mov_b32 s93, 9216
  s_mov_b32 s94, 12288
  s_mov_b32 s95, 15360
  s_mov_b32 s96, 18432
  s_mov_b32 s97, 21504
  v_lshlrev_b32 v1, 4, v0
  s_mul_i32 s63, s60, 24576
  v_add_u32 v9, s63, v1
  v_and_b32 v1, 31, v0
  v_mul_u32_u24 v1, 12, v1
  v_lshrrev_b32 v2, 5, v0
  v_mul_u32_u24 v2, 245760, v2
  v_add_u32 v1, v1, v2
  s_mul_i32 s63, s60, 491520
  v_add_u32 v15, s63, v1
  s_waitcnt lgkmcnt(0)
  s_mul_i32 s63, s62, 384
  s_sub_u32 s89, 7864320, s63
  s_add_u32 s32, s10, s63
  s_addc_u32 s33, s11, 0
  s_and_b32 s33, s33, 0xffff
  s_mov_b32 s34, s89
  s_mov_b32 s35, 0x00020000
  s_mul_i32 s63, s2, 1572864
  s_add_u32 s63, s63, 1179648
  s_add_u32 s24, s6, s63
  s_addc_u32 s25, s7, 0
  s_and_b32 s25, s25, 0xffff
  s_mov_b32 s26, 393216
  s_mov_b32 s27, 0x00020000
  s_mov_b32 s84, 0
  buffer_load_dwordx3 v[24:26], v15, s[32:35], s84 offen
  s_mov_b32 s84, 12288
  buffer_load_dwordx3 v[28:30], v15, s[32:35], s84 offen
  s_mov_b32 s84, 24576
  buffer_load_dwordx3 v[32:34], v15, s[32:35], s84 offen
  s_mov_b32 s84, 36864
  buffer_load_dwordx3 v[36:38], v15, s[32:35], s84 offen
  s_mov_b32 s84, 49152
  buffer_load_dwordx3 v[40:42], v15, s[32:35], s84 offen
  s_mov_b32 s84, 61440
  buffer_load_dwordx3 v[44:46], v15, s[32:35], s84 offen
  s_mov_b32 s84, 73728
  buffer_load_dwordx3 v[48:50], v15, s[32:35], s84 offen
  s_mov_b32 s84, 86016
  buffer_load_dwordx3 v[52:54], v15, s[32:35], s84 offen
  s_mov_b32 s84, 98304
  buffer_load_dwordx3 v[56:58], v15, s[32:35], s84 offen
  s_mov_b32 s84, 110592
  buffer_load_dwordx3 v[60:62], v15, s[32:35], s84 offen
  s_mov_b32 s84, 122880
  buffer_load_dwordx3 v[64:66], v15, s[32:35], s84 offen
  s_mov_b32 s84, 135168
  buffer_load_dwordx3 v[68:70], v15, s[32:35], s84 offen
  s_mov_b32 s84, 147456
  buffer_load_dwordx3 v[72:74], v15, s[32:35], s84 offen
  s_mov_b32 s84, 159744
  buffer_load_dwordx3 v[76:78], v15, s[32:35], s84 offen
  s_mov_b32 s84, 172032
  buffer_load_dwordx3 v[80:82], v15, s[32:35], s84 offen
  s_mov_b32 s84, 184320
  buffer_load_dwordx3 v[84:86], v15, s[32:35], s84 offen
  s_mov_b32 s84, 196608
  buffer_load_dwordx3 v[88:90], v15, s[32:35], s84 offen
  s_mov_b32 s84, 208896
  buffer_load_dwordx3 v[92:94], v15, s[32:35], s84 offen
  s_mov_b32 s84, 221184
  buffer_load_dwordx3 v[96:98], v15, s[32:35], s84 offen
  s_mov_b32 s84, 233472
  buffer_load_dwordx3 v[100:102], v15, s[32:35], s84 offen
  s_mov_b32 s56, s4
  s_and_b32 s57, s5, 0xffff
  s_mov_b32 s58, 10240
  s_mov_b32 s59, 0x00020000
  s_lshl_b32 s89, s60, 6
  v_add_u32 v1, s89, v0
  s_mul_i32 s89, s61, 1280
  v_lshlrev_b32 v2, 1, v1
  v_add_u32 v2, s89, v2
  buffer_load_ushort v23, v2, s[56:59], 0 offen
  v_lshlrev_b32 v22, 2, v1
  s_barrier
  buffer_load_dwordx4 v[104:107], v9, s[24:27], 0 offen offset:0 nt
  buffer_load_dwordx4 v[108:111], v9, s[24:27], 0 offen offset:1024 nt
  buffer_load_dwordx4 v[112:115], v9, s[24:27], 0 offen offset:2048 nt
  buffer_load_dwordx4 v[116:119], v9, s[24:27], s91 offen offset:0 nt
  buffer_load_dwordx4 v[120:123], v9, s[24:27], s91 offen offset:1024 nt
  buffer_load_dwordx4 v[124:127], v9, s[24:27], s91 offen offset:2048 nt
  s_add_u32 s28, s8, s63
  s_addc_u32 s29, s9, 0
  s_and_b32 s29, s29, 0xffff
  s_mov_b32 s30, 393216
  s_mov_b32 s31, 0x00020000
  s_mul_i32 s63, s62, 96
  s_sub_u32 s89, 1966080, s63
  s_add_u32 s36, s16, s63
  s_addc_u32 s37, s17, 0
  s_and_b32 s37, s37, 0xffff
  s_mov_b32 s38, s89
  s_mov_b32 s39, 0x00020000
  s_add_u32 s40, s18, s63
  s_addc_u32 s41, s19, 0
  s_and_b32 s41, s41, 0xffff
  s_mov_b32 s42, s89
  s_mov_b32 s43, 0x00020000
  s_mul_i32 s63, s62, 245760
  s_add_u32 s44, s12, s63
  s_addc_u32 s45, s13, 0
  s_and_b32 s45, s45, 0xffff
  s_mov_b32 s46, 245760
  s_mov_b32 s47, 0x00020000
  s_mul_i32 s63, s62, 61440
  s_add_u32 s48, s20, s63
  s_addc_u32 s49, s21, 0
  s_and_b32 s49, s49, 0xffff
  s_mov_b32 s50, 61440
  s_mov_b32 s51, 0x00020000
  s_mov_b32 s52, s22
  s_and_b32 s53, s23, 0xffff
  s_mov_b32 s54, 8388608
  s_mov_b32 s55, 0x00020000
  s_mul_i32 s63, s61, 1280
  s_mul_i32 s89, s60, 80
  s_add_u32 s63, s63, s89
  s_add_u32 s4, s4, s63
  s_addc_u32 s5, s5, 0
  s_load_dwordx4 s[64:67], s[4:5], 0
  s_load_dwordx4 s[68:71], s[4:5], 16
  s_load_dwordx4 s[72:75], s[4:5], 32
  s_load_dwordx4 s[76:79], s[4:5], 48
  s_load_dwordx4 s[80:83], s[4:5], 64
  s_waitcnt lgkmcnt(0)
  s_mov_b32 vcc_lo, 0
  s_mov_b32 vcc_hi, -1
  s_waitcnt vmcnt(25)
  v_mov_b32 v3, s74
  v_mov_b32 v8, s64
  v_cndmask_b32 v3, v8, v3, vcc
  v_perm_b32 v4, v28, v24, s85
  v_perm_b32 v5, v28, v24, s86
  v_dot2_f32_bf16 v16, v4, v3, 0
  v_dot2_f32_bf16 v17, v5, v3, 0
  v_perm_b32 v6, v29, v25, s85
  v_perm_b32 v7, v29, v25, s86
  v_dot2_f32_bf16 v18, v6, v3, 0
  v_dot2_f32_bf16 v19, v7, v3, 0
  v_perm_b32 v4, v30, v26, s85
  v_perm_b32 v5, v30, v26, s86
  v_dot2_f32_bf16 v20, v4, v3, 0
  v_dot2_f32_bf16 v21, v5, v3, 0
  s_waitcnt vmcnt(23)
  v_mov_b32 v3, s75
  v_mov_b32 v8, s65
  v_cndmask_b32 v3, v8, v3, vcc
  v_perm_b32 v4, v36, v32, s85
  v_perm_b32 v5, v36, v32, s86
  v_dot2_f32_bf16 v16, v4, v3, v16
  v_dot2_f32_bf16 v17, v5, v3, v17
  v_perm_b32 v6, v37, v33, s85
  v_perm_b32 v7, v37, v33, s86
  v_dot2_f32_bf16 v18, v6, v3, v18
  v_dot2_f32_bf16 v19, v7, v3, v19
  v_perm_b32 v4, v38, v34, s85
  v_perm_b32 v5, v38, v34, s86
  v_dot2_f32_bf16 v20, v4, v3, v20
  v_dot2_f32_bf16 v21, v5, v3, v21
  s_waitcnt vmcnt(21)
  v_mov_b32 v3, s76
  v_mov_b32 v8, s66
  v_cndmask_b32 v3, v8, v3, vcc
  v_perm_b32 v4, v44, v40, s85
  v_perm_b32 v5, v44, v40, s86
  v_dot2_f32_bf16 v16, v4, v3, v16
  v_dot2_f32_bf16 v17, v5, v3, v17
  v_perm_b32 v6, v45, v41, s85
  v_perm_b32 v7, v45, v41, s86
  v_dot2_f32_bf16 v18, v6, v3, v18
  v_dot2_f32_bf16 v19, v7, v3, v19
  v_perm_b32 v4, v46, v42, s85
  v_perm_b32 v5, v46, v42, s86
  v_dot2_f32_bf16 v20, v4, v3, v20
  v_dot2_f32_bf16 v21, v5, v3, v21
  s_waitcnt vmcnt(19)
  v_mov_b32 v3, s77
  v_mov_b32 v8, s67
  v_cndmask_b32 v3, v8, v3, vcc
  v_perm_b32 v4, v52, v48, s85
  v_perm_b32 v5, v52, v48, s86
  v_dot2_f32_bf16 v16, v4, v3, v16
  v_dot2_f32_bf16 v17, v5, v3, v17
  v_perm_b32 v6, v53, v49, s85
  v_perm_b32 v7, v53, v49, s86
  v_dot2_f32_bf16 v18, v6, v3, v18
  v_dot2_f32_bf16 v19, v7, v3, v19
  v_perm_b32 v4, v54, v50, s85
  v_perm_b32 v5, v54, v50, s86
  v_dot2_f32_bf16 v20, v4, v3, v20
  v_dot2_f32_bf16 v21, v5, v3, v21
  buffer_load_dwordx4 v[32:35], v9, s[24:27], s92 offen offset:0 nt
  buffer_load_dwordx4 v[36:39], v9, s[24:27], s92 offen offset:1024 nt
  buffer_load_dwordx4 v[40:43], v9, s[24:27], s92 offen offset:2048 nt
  buffer_load_dwordx4 v[44:47], v9, s[24:27], s93 offen offset:0 nt
  buffer_load_dwordx4 v[48:51], v9, s[24:27], s93 offen offset:1024 nt
  buffer_load_dwordx4 v[52:55], v9, s[24:27], s93 offen offset:2048 nt
  s_waitcnt vmcnt(23)
  v_mov_b32 v3, s78
  v_mov_b32 v8, s68
  v_cndmask_b32 v3, v8, v3, vcc
  v_perm_b32 v4, v60, v56, s85
  v_perm_b32 v5, v60, v56, s86
  v_dot2_f32_bf16 v16, v4, v3, v16
  v_dot2_f32_bf16 v17, v5, v3, v17
  v_perm_b32 v6, v61, v57, s85
  v_perm_b32 v7, v61, v57, s86
  v_dot2_f32_bf16 v18, v6, v3, v18
  v_dot2_f32_bf16 v19, v7, v3, v19
  v_perm_b32 v4, v62, v58, s85
  v_perm_b32 v5, v62, v58, s86
  v_dot2_f32_bf16 v20, v4, v3, v20
  v_dot2_f32_bf16 v21, v5, v3, v21
  s_waitcnt vmcnt(21)
  v_mov_b32 v3, s79
  v_mov_b32 v8, s69
  v_cndmask_b32 v3, v8, v3, vcc
  v_perm_b32 v4, v68, v64, s85
  v_perm_b32 v5, v68, v64, s86
  v_dot2_f32_bf16 v16, v4, v3, v16
  v_dot2_f32_bf16 v17, v5, v3, v17
  v_perm_b32 v6, v69, v65, s85
  v_perm_b32 v7, v69, v65, s86
  v_dot2_f32_bf16 v18, v6, v3, v18
  v_dot2_f32_bf16 v19, v7, v3, v19
  v_perm_b32 v4, v70, v66, s85
  v_perm_b32 v5, v70, v66, s86
  v_dot2_f32_bf16 v20, v4, v3, v20
  v_dot2_f32_bf16 v21, v5, v3, v21
  s_waitcnt vmcnt(19)
  v_mov_b32 v3, s80
  v_mov_b32 v8, s70
  v_cndmask_b32 v3, v8, v3, vcc
  v_perm_b32 v4, v76, v72, s85
  v_perm_b32 v5, v76, v72, s86
  v_dot2_f32_bf16 v16, v4, v3, v16
  v_dot2_f32_bf16 v17, v5, v3, v17
  v_perm_b32 v6, v77, v73, s85
  v_perm_b32 v7, v77, v73, s86
  v_dot2_f32_bf16 v18, v6, v3, v18
  v_dot2_f32_bf16 v19, v7, v3, v19
  v_perm_b32 v4, v78, v74, s85
  v_perm_b32 v5, v78, v74, s86
  v_dot2_f32_bf16 v20, v4, v3, v20
  v_dot2_f32_bf16 v21, v5, v3, v21
  s_waitcnt vmcnt(17)
  v_mov_b32 v3, s81
  v_mov_b32 v8, s71
  v_cndmask_b32 v3, v8, v3, vcc
  v_perm_b32 v4, v84, v80, s85
  v_perm_b32 v5, v84, v80, s86
  v_dot2_f32_bf16 v16, v4, v3, v16
  v_dot2_f32_bf16 v17, v5, v3, v17
  v_perm_b32 v6, v85, v81, s85
  v_perm_b32 v7, v85, v81, s86
  v_dot2_f32_bf16 v18, v6, v3, v18
  v_dot2_f32_bf16 v19, v7, v3, v19
  v_perm_b32 v4, v86, v82, s85
  v_perm_b32 v5, v86, v82, s86
  v_dot2_f32_bf16 v20, v4, v3, v20
  v_dot2_f32_bf16 v21, v5, v3, v21
  s_waitcnt vmcnt(15)
  v_mov_b32 v3, s82
  v_mov_b32 v8, s72
  v_cndmask_b32 v3, v8, v3, vcc
  v_perm_b32 v4, v92, v88, s85
  v_perm_b32 v5, v92, v88, s86
  v_dot2_f32_bf16 v16, v4, v3, v16
  v_dot2_f32_bf16 v17, v5, v3, v17
  v_perm_b32 v6, v93, v89, s85
  v_perm_b32 v7, v93, v89, s86
  v_dot2_f32_bf16 v18, v6, v3, v18
  v_dot2_f32_bf16 v19, v7, v3, v19
  v_perm_b32 v4, v94, v90, s85
  v_perm_b32 v5, v94, v90, s86
  v_dot2_f32_bf16 v20, v4, v3, v20
  v_dot2_f32_bf16 v21, v5, v3, v21
  s_waitcnt vmcnt(13)
  v_mov_b32 v3, s83
  v_mov_b32 v8, s73
  v_cndmask_b32 v3, v8, v3, vcc
  v_perm_b32 v4, v100, v96, s85
  v_perm_b32 v5, v100, v96, s86
  v_dot2_f32_bf16 v16, v4, v3, v16
  v_dot2_f32_bf16 v17, v5, v3, v17
  v_perm_b32 v6, v101, v97, s85
  v_perm_b32 v7, v101, v97, s86
  v_dot2_f32_bf16 v18, v6, v3, v18
  v_dot2_f32_bf16 v19, v7, v3, v19
  v_perm_b32 v4, v102, v98, s85
  v_perm_b32 v5, v102, v98, s86
  v_dot2_f32_bf16 v20, v4, v3, v20
  v_dot2_f32_bf16 v21, v5, v3, v21
  v_and_b32 v1, 31, v0
  v_mul_u32_u24 v1, 24, v1
  v_lshrrev_b32 v2, 5, v0
  v_mul_u32_u24 v2, 768, v2
  v_add_u32 v1, v1, v2
  s_mul_i32 s63, s60, 1536
  v_add_u32 v1, s63, v1
  ds_write_b64 v1, v[16:17] offset:0
  ds_write_b64 v1, v[18:19] offset:8
  ds_write_b64 v1, v[20:21] offset:16
  s_waitcnt vmcnt(12)
  v_lshlrev_b32 v23, 16, v23
  ds_write_b32 v22, v23 offset:30720
  s_waitcnt lgkmcnt(0)
  s_barrier
  s_cmp_ge_u32 s60, 3
  s_cbranch_scc1 L_a_finq_done
  s_lshl_b32 s63, s60, 8
  v_lshlrev_b32 v1, 2, v0
  v_add_u32 v1, s63, v1
  v_mov_b32 v2, 0
  ds_read_b32 v80, v1 offset:0
  ds_read_b32 v81, v1 offset:768
  ds_read_b32 v82, v1 offset:1536
  ds_read_b32 v83, v1 offset:2304
  ds_read_b32 v84, v1 offset:3072
  ds_read_b32 v85, v1 offset:3840
  ds_read_b32 v86, v1 offset:4608
  ds_read_b32 v87, v1 offset:5376
  ds_read_b32 v88, v1 offset:6144
  ds_read_b32 v89, v1 offset:6912
  ds_read_b32 v90, v1 offset:7680
  ds_read_b32 v91, v1 offset:8448
  ds_read_b32 v92, v1 offset:9216
  ds_read_b32 v93, v1 offset:9984
  ds_read_b32 v94, v1 offset:10752
  ds_read_b32 v95, v1 offset:11520
  s_waitcnt lgkmcnt(0)
  v_add_f32 v2, v2, v80
  v_add_f32 v2, v2, v81
  v_add_f32 v2, v2, v82
  v_add_f32 v2, v2, v83
  v_add_f32 v2, v2, v84
  v_add_f32 v2, v2, v85
  v_add_f32 v2, v2, v86
  v_add_f32 v2, v2, v87
  v_add_f32 v2, v2, v88
  v_add_f32 v2, v2, v89
  v_add_f32 v2, v2, v90
  v_add_f32 v2, v2, v91
  v_add_f32 v2, v2, v92
  v_add_f32 v2, v2, v93
  v_add_f32 v2, v2, v94
  v_add_f32 v2, v2, v95
  ds_read_b32 v80, v1 offset:12288
  ds_read_b32 v81, v1 offset:13056
  ds_read_b32 v82, v1 offset:13824
  ds_read_b32 v83, v1 offset:14592
  ds_read_b32 v84, v1 offset:15360
  ds_read_b32 v85, v1 offset:16128
  ds_read_b32 v86, v1 offset:16896
  ds_read_b32 v87, v1 offset:17664
  ds_read_b32 v88, v1 offset:18432
  ds_read_b32 v89, v1 offset:19200
  ds_read_b32 v90, v1 offset:19968
  ds_read_b32 v91, v1 offset:20736
  ds_read_b32 v92, v1 offset:21504
  ds_read_b32 v93, v1 offset:22272
  ds_read_b32 v94, v1 offset:23040
  ds_read_b32 v95, v1 offset:23808
  s_waitcnt lgkmcnt(0)
  v_add_f32 v2, v2, v80
  v_add_f32 v2, v2, v81
  v_add_f32 v2, v2, v82
  v_add_f32 v2, v2, v83
  v_add_f32 v2, v2, v84
  v_add_f32 v2, v2, v85
  v_add_f32 v2, v2, v86
  v_add_f32 v2, v2, v87
  v_add_f32 v2, v2, v88
  v_add_f32 v2, v2, v89
  v_add_f32 v2, v2, v90
  v_add_f32 v2, v2, v91
  v_add_f32 v2, v2, v92
  v_add_f32 v2, v2, v93
  v_add_f32 v2, v2, v94
  v_add_f32 v2, v2, v95
  v_cvt_pk_bf16_f32 v2, v2, v2
  v_lshrrev_b32 v1, 1, v1
  ds_write_b16 v1, v2 offset:34816
L_a_finq_done:
  s_nop 4
  s_waitcnt lgkmcnt(0)
  s_barrier
  v_lshrrev_b32 v1, 4, v0
  v_lshlrev_b32 v1, 4, v1
  ds_read_b128 v[80:83], v1 offset:34816
  ds_read_b128 v[84:87], v1 offset:34880
  ds_read_b128 v[88:91], v1 offset:34944
  ds_read_b128 v[92:95], v1 offset:35008
  ds_read_b128 v[96:99], v1 offset:35072
  ds_read_b128 v[100:103], v1 offset:35136
  v_add_u32 v1, 0, v0
  v_mul_u32_u24 v2, 2731, v1
  v_lshrrev_b32 v2, 16, v2
  v_mul_u32_u24 v3, 24, v2
  v_sub_u32 v1, v1, v3
  v_lshlrev_b32 v1, 4, v1
  v_mul_u32_u24 v2, 400, v2
  v_add_u32 v1, v1, v2
  s_mul_i32 s63, s60, 6400
  s_add_u32 s63, s63, 36864
  v_add_u32 v56, s63, v1
  v_add_u32 v1, 64, v0
  v_mul_u32_u24 v2, 2731, v1
  v_lshrrev_b32 v2, 16, v2
  v_mul_u32_u24 v3, 24, v2
  v_sub_u32 v1, v1, v3
  v_lshlrev_b32 v1, 4, v1
  v_mul_u32_u24 v2, 400, v2
  v_add_u32 v1, v1, v2
  s_mul_i32 s63, s60, 6400
  s_add_u32 s63, s63, 36864
  v_add_u32 v57, s63, v1
  v_add_u32 v1, 128, v0
  v_mul_u32_u24 v2, 2731, v1
  v_lshrrev_b32 v2, 16, v2
  v_mul_u32_u24 v3, 24, v2
  v_sub_u32 v1, v1, v3
  v_lshlrev_b32 v1, 4, v1
  v_mul_u32_u24 v2, 400, v2
  v_add_u32 v1, v1, v2
  s_mul_i32 s63, s60, 6400
  s_add_u32 s63, s63, 36864
  v_add_u32 v58, s63, v1
  v_and_b32 v1, 15, v0
  v_mul_u32_u24 v1, 400, v1
  v_lshrrev_b32 v2, 4, v0
  v_lshlrev_b32 v2, 4, v2
  v_add_u32 v1, v1, v2
  v_add_u32 v59, s63, v1
  v_and_b32 v1, 31, v0
  v_min_u32 v1, 23, v1
  v_lshlrev_b32 v1, 4, v1
  v_lshrrev_b32 v2, 5, v0
  v_mul_u32_u24 v2, 3200, v2
  v_add_u32 v1, v1, v2
  v_add_u32 v60, s63, v1
  v_and_b32 v13, 7, v0
  v_mul_u32_u24 v1, 20, v13
  v_mul_u32_u24 v13, 15360, v13
  v_lshrrev_b32 v2, 3, v0
  v_mul_u32_u24 v2, 12, v2
  v_add_u32 v13, v13, v2
  s_mul_i32 s63, s60, 122880
  v_add_u32 v13, s63, v13
  s_mul_i32 s63, s60, 160
  v_add_u32 v14, s63, v1
  s_waitcnt vmcnt(6)
  ds_write_b128 v56, v[104:107] offset:0
  ds_write_b128 v57, v[108:111] offset:0
  ds_write_b128 v58, v[112:115] offset:0
  ds_write_b128 v56, v[116:119] offset:3200
  ds_write_b128 v57, v[120:123] offset:3200
  ds_write_b128 v58, v[124:127] offset:3200
  s_waitcnt lgkmcnt(0)
  ds_read_b128 v[104:107], v59 offset:0
  ds_read_b128 v[108:111], v59 offset:64
  ds_read_b128 v[112:115], v59 offset:128
  ds_read_b128 v[116:119], v59 offset:192
  ds_read_b128 v[120:123], v59 offset:256
  ds_read_b128 v[124:127], v59 offset:320
  s_waitcnt lgkmcnt(0)
  v_mfma_f32_16x16x32_bf16 v[4:7], v[80:83], v[104:107], 0
  v_mfma_f32_16x16x32_bf16 v[4:7], v[84:87], v[108:111], v[4:7]
  v_mfma_f32_16x16x32_bf16 v[4:7], v[88:91], v[112:115], v[4:7]
  v_mfma_f32_16x16x32_bf16 v[4:7], v[92:95], v[116:119], v[4:7]
  v_mfma_f32_16x16x32_bf16 v[4:7], v[96:99], v[120:123], v[4:7]
  v_mfma_f32_16x16x32_bf16 v[4:7], v[100:103], v[124:127], v[4:7]
  buffer_load_dwordx3 v[64:66], v13, s[36:39], 0 offen
  buffer_load_dwordx3 v[68:70], v13, s[36:39], s91 offen
  buffer_load_dwordx3 v[72:74], v13, s[36:39], s92 offen
  buffer_load_dwordx3 v[76:78], v13, s[36:39], s93 offen
  buffer_load_dwordx4 v[104:107], v9, s[24:27], s94 offen offset:0 nt
  buffer_load_dwordx4 v[108:111], v9, s[24:27], s94 offen offset:1024 nt
  buffer_load_dwordx4 v[112:115], v9, s[24:27], s94 offen offset:2048 nt
  buffer_load_dwordx4 v[116:119], v9, s[24:27], s95 offen offset:0 nt
  buffer_load_dwordx4 v[120:123], v9, s[24:27], s95 offen offset:1024 nt
  buffer_load_dwordx4 v[124:127], v9, s[24:27], s95 offen offset:2048 nt
  v_cvt_pk_bf16_f32 v1, v4, v4
  v_lshlrev_b32 v1, 16, v1
  v_mul_f32 v1, s87, v1
  v_cvt_pk_bf16_f32 v1, v1, v1
  v_lshlrev_b32 v1, 16, v1
  v_mul_f32 v24, s88, v1
  s_waitcnt vmcnt(10)
  ds_write_b128 v56, v[32:35] offset:0
  ds_write_b128 v57, v[36:39] offset:0
  ds_write_b128 v58, v[40:43] offset:0
  ds_write_b128 v56, v[44:47] offset:3200
  ds_write_b128 v57, v[48:51] offset:3200
  ds_write_b128 v58, v[52:55] offset:3200
  s_waitcnt lgkmcnt(0)
  ds_read_b128 v[32:35], v59 offset:0
  ds_read_b128 v[36:39], v59 offset:64
  ds_read_b128 v[40:43], v59 offset:128
  ds_read_b128 v[44:47], v59 offset:192
  ds_read_b128 v[48:51], v59 offset:256
  ds_read_b128 v[52:55], v59 offset:320
  s_waitcnt lgkmcnt(0)
  v_mfma_f32_16x16x32_bf16 v[4:7], v[80:83], v[32:35], 0
  v_mfma_f32_16x16x32_bf16 v[4:7], v[84:87], v[36:39], v[4:7]
  v_mfma_f32_16x16x32_bf16 v[4:7], v[88:91], v[40:43], v[4:7]
  v_mfma_f32_16x16x32_bf16 v[4:7], v[92:95], v[44:47], v[4:7]
  v_mfma_f32_16x16x32_bf16 v[4:7], v[96:99], v[48:51], v[4:7]
  v_mfma_f32_16x16x32_bf16 v[4:7], v[100:103], v[52:55], v[4:7]
  ds_read_b32 v67, v14 offset:30720
  ds_read_b32 v71, v14 offset:30724
  ds_read_b32 v75, v14 offset:30728
  ds_read_b32 v79, v14 offset:30732
  s_waitcnt vmcnt(6)
  s_waitcnt lgkmcnt(0)
  v_lshlrev_b32 v1, 16, v64
  v_and_b32 v2, 0xffff0000, v64
  v_mul_f32 v16, v1, v67
  v_mul_f32 v17, v2, v67
  v_lshlrev_b32 v1, 16, v65
  v_and_b32 v2, 0xffff0000, v65
  v_mul_f32 v18, v1, v67
  v_mul_f32 v19, v2, v67
  v_lshlrev_b32 v1, 16, v66
  v_and_b32 v2, 0xffff0000, v66
  v_mul_f32 v20, v1, v67
  v_mul_f32 v21, v2, v67
  v_lshlrev_b32 v1, 16, v68
  v_and_b32 v2, 0xffff0000, v68
  v_fmac_f32 v16, v1, v71
  v_fmac_f32 v17, v2, v71
  v_lshlrev_b32 v1, 16, v69
  v_and_b32 v2, 0xffff0000, v69
  v_fmac_f32 v18, v1, v71
  v_fmac_f32 v19, v2, v71
  v_lshlrev_b32 v1, 16, v70
  v_and_b32 v2, 0xffff0000, v70
  v_fmac_f32 v20, v1, v71
  v_fmac_f32 v21, v2, v71
  v_lshlrev_b32 v1, 16, v72
  v_and_b32 v2, 0xffff0000, v72
  v_fmac_f32 v16, v1, v75
  v_fmac_f32 v17, v2, v75
  v_lshlrev_b32 v1, 16, v73
  v_and_b32 v2, 0xffff0000, v73
  v_fmac_f32 v18, v1, v75
  v_fmac_f32 v19, v2, v75
  v_lshlrev_b32 v1, 16, v74
  v_and_b32 v2, 0xffff0000, v74
  v_fmac_f32 v20, v1, v75
  v_fmac_f32 v21, v2, v75
  v_lshlrev_b32 v1, 16, v76
  v_and_b32 v2, 0xffff0000, v76
  v_fmac_f32 v16, v1, v79
  v_fmac_f32 v17, v2, v79
  v_lshlrev_b32 v1, 16, v77
  v_and_b32 v2, 0xffff0000, v77
  v_fmac_f32 v18, v1, v79
  v_fmac_f32 v19, v2, v79
  v_lshlrev_b32 v1, 16, v78
  v_and_b32 v2, 0xffff0000, v78
  v_fmac_f32 v20, v1, v79
  v_fmac_f32 v21, v2, v79
  buffer_load_dwordx3 v[64:66], v13, s[36:39], s94 offen
  buffer_load_dwordx4 v[32:35], v9, s[24:27], s96 offen offset:0 nt
  buffer_load_dwordx4 v[36:39], v9, s[24:27], s96 offen offset:1024 nt
  buffer_load_dwordx4 v[40:43], v9, s[24:27], s96 offen offset:2048 nt
  buffer_load_dwordx4 v[44:47], v9, s[24:27], s97 offen offset:0 nt
  buffer_load_dwordx4 v[48:51], v9, s[24:27], s97 offen offset:1024 nt
  buffer_load_dwordx4 v[52:55], v9, s[24:27], s97 offen offset:2048 nt
  v_cvt_pk_bf16_f32 v1, v4, v4
  v_lshlrev_b32 v1, 16, v1
  v_mul_f32 v1, s87, v1
  v_cvt_pk_bf16_f32 v1, v1, v1
  v_lshlrev_b32 v1, 16, v1
  v_mul_f32 v25, s88, v1
  s_waitcnt vmcnt(7)
  ds_write_b128 v56, v[104:107] offset:0
  ds_write_b128 v57, v[108:111] offset:0
  ds_write_b128 v58, v[112:115] offset:0
  ds_write_b128 v56, v[116:119] offset:3200
  ds_write_b128 v57, v[120:123] offset:3200
  ds_write_b128 v58, v[124:127] offset:3200
  s_waitcnt lgkmcnt(0)
  ds_read_b128 v[104:107], v59 offset:0
  ds_read_b128 v[108:111], v59 offset:64
  ds_read_b128 v[112:115], v59 offset:128
  ds_read_b128 v[116:119], v59 offset:192
  ds_read_b128 v[120:123], v59 offset:256
  ds_read_b128 v[124:127], v59 offset:320
  s_waitcnt lgkmcnt(0)
  v_mfma_f32_16x16x32_bf16 v[4:7], v[80:83], v[104:107], 0
  v_mfma_f32_16x16x32_bf16 v[4:7], v[84:87], v[108:111], v[4:7]
  v_mfma_f32_16x16x32_bf16 v[4:7], v[88:91], v[112:115], v[4:7]
  v_mfma_f32_16x16x32_bf16 v[4:7], v[92:95], v[116:119], v[4:7]
  v_mfma_f32_16x16x32_bf16 v[4:7], v[96:99], v[120:123], v[4:7]
  v_mfma_f32_16x16x32_bf16 v[4:7], v[100:103], v[124:127], v[4:7]
  ds_read_b32 v67, v14 offset:30736
  s_waitcnt vmcnt(6)
  s_waitcnt lgkmcnt(0)
  v_lshlrev_b32 v1, 16, v64
  v_and_b32 v2, 0xffff0000, v64
  v_fmac_f32 v16, v1, v67
  v_fmac_f32 v17, v2, v67
  v_lshlrev_b32 v1, 16, v65
  v_and_b32 v2, 0xffff0000, v65
  v_fmac_f32 v18, v1, v67
  v_fmac_f32 v19, v2, v67
  v_lshlrev_b32 v1, 16, v66
  v_and_b32 v2, 0xffff0000, v66
  v_fmac_f32 v20, v1, v67
  v_fmac_f32 v21, v2, v67
  v_add_f32_dpp v16, v16, v16 quad_perm:[1,0,3,2] row_mask:0xf bank_mask:0xf
  v_add_f32_dpp v17, v17, v17 quad_perm:[1,0,3,2] row_mask:0xf bank_mask:0xf
  v_add_f32_dpp v18, v18, v18 quad_perm:[1,0,3,2] row_mask:0xf bank_mask:0xf
  v_add_f32_dpp v19, v19, v19 quad_perm:[1,0,3,2] row_mask:0xf bank_mask:0xf
  v_add_f32_dpp v20, v20, v20 quad_perm:[1,0,3,2] row_mask:0xf bank_mask:0xf
  v_add_f32_dpp v21, v21, v21 quad_perm:[1,0,3,2] row_mask:0xf bank_mask:0xf
  v_add_f32_dpp v16, v16, v16 quad_perm:[2,3,0,1] row_mask:0xf bank_mask:0xf
  v_add_f32_dpp v17, v17, v17 quad_perm:[2,3,0,1] row_mask:0xf bank_mask:0xf
  v_add_f32_dpp v18, v18, v18 quad_perm:[2,3,0,1] row_mask:0xf bank_mask:0xf
  v_add_f32_dpp v19, v19, v19 quad_perm:[2,3,0,1] row_mask:0xf bank_mask:0xf
  v_add_f32_dpp v20, v20, v20 quad_perm:[2,3,0,1] row_mask:0xf bank_mask:0xf
  v_add_f32_dpp v21, v21, v21 quad_perm:[2,3,0,1] row_mask:0xf bank_mask:0xf
  v_add_f32_dpp v16, v16, v16 row_half_mirror row_mask:0xf bank_mask:0xf
  v_add_f32_dpp v17, v17, v17 row_half_mirror row_mask:0xf bank_mask:0xf
  v_add_f32_dpp v18, v18, v18 row_half_mirror row_mask:0xf bank_mask:0xf
  v_add_f32_dpp v19, v19, v19 row_half_mirror row_mask:0xf bank_mask:0xf
  v_add_f32_dpp v20, v20, v20 row_half_mirror row_mask:0xf bank_mask:0xf
  v_add_f32_dpp v21, v21, v21 row_half_mirror row_mask:0xf bank_mask:0xf
  v_lshrrev_b32 v1, 3, v0
  v_mul_u32_u24 v1, 24, v1
  s_mul_i32 s63, s60, 192
  v_add_u32 v1, s63, v1
  ds_write_b64 v1, v[16:17] offset:24576
  ds_write_b64 v1, v[18:19] offset:24584
  ds_write_b64 v1, v[20:21] offset:24592
  buffer_load_dwordx3 v[64:66], v13, s[40:43], 0 offen
  buffer_load_dwordx3 v[68:70], v13, s[40:43], s91 offen
  buffer_load_dwordx3 v[72:74], v13, s[40:43], s92 offen
  buffer_load_dwordx3 v[76:78], v13, s[40:43], s93 offen
  buffer_load_dwordx4 v[104:107], v9, s[28:31], 0 offen offset:0 nt
  buffer_load_dwordx4 v[108:111], v9, s[28:31], 0 offen offset:1024 nt
  buffer_load_dwordx4 v[112:115], v9, s[28:31], 0 offen offset:2048 nt
  buffer_load_dwordx4 v[116:119], v9, s[28:31], s91 offen offset:0 nt
  buffer_load_dwordx4 v[120:123], v9, s[28:31], s91 offen offset:1024 nt
  buffer_load_dwordx4 v[124:127], v9, s[28:31], s91 offen offset:2048 nt
  v_cvt_pk_bf16_f32 v1, v4, v4
  v_lshlrev_b32 v1, 16, v1
  v_mul_f32 v1, s87, v1
  v_cvt_pk_bf16_f32 v1, v1, v1
  v_lshlrev_b32 v1, 16, v1
  v_mul_f32 v26, s88, v1
  s_waitcnt vmcnt(10)
  ds_write_b128 v56, v[32:35] offset:0
  ds_write_b128 v57, v[36:39] offset:0
  ds_write_b128 v58, v[40:43] offset:0
  ds_write_b128 v56, v[44:47] offset:3200
  ds_write_b128 v57, v[48:51] offset:3200
  ds_write_b128 v58, v[52:55] offset:3200
  s_waitcnt lgkmcnt(0)
  ds_read_b128 v[32:35], v59 offset:0
  ds_read_b128 v[36:39], v59 offset:64
  ds_read_b128 v[40:43], v59 offset:128
  ds_read_b128 v[44:47], v59 offset:192
  ds_read_b128 v[48:51], v59 offset:256
  ds_read_b128 v[52:55], v59 offset:320
  s_waitcnt lgkmcnt(0)
  v_mfma_f32_16x16x32_bf16 v[4:7], v[80:83], v[32:35], 0
  v_mfma_f32_16x16x32_bf16 v[4:7], v[84:87], v[36:39], v[4:7]
  v_mfma_f32_16x16x32_bf16 v[4:7], v[88:91], v[40:43], v[4:7]
  v_mfma_f32_16x16x32_bf16 v[4:7], v[92:95], v[44:47], v[4:7]
  v_mfma_f32_16x16x32_bf16 v[4:7], v[96:99], v[48:51], v[4:7]
  v_mfma_f32_16x16x32_bf16 v[4:7], v[100:103], v[52:55], v[4:7]
  ds_read_b32 v67, v14 offset:30720
  ds_read_b32 v71, v14 offset:30724
  ds_read_b32 v75, v14 offset:30728
  ds_read_b32 v79, v14 offset:30732
  s_waitcnt vmcnt(6)
  s_waitcnt lgkmcnt(0)
  v_lshlrev_b32 v1, 16, v64
  v_and_b32 v2, 0xffff0000, v64
  v_mul_f32 v16, v1, v67
  v_mul_f32 v17, v2, v67
  v_lshlrev_b32 v1, 16, v65
  v_and_b32 v2, 0xffff0000, v65
  v_mul_f32 v18, v1, v67
  v_mul_f32 v19, v2, v67
  v_lshlrev_b32 v1, 16, v66
  v_and_b32 v2, 0xffff0000, v66
  v_mul_f32 v20, v1, v67
  v_mul_f32 v21, v2, v67
  v_lshlrev_b32 v1, 16, v68
  v_and_b32 v2, 0xffff0000, v68
  v_fmac_f32 v16, v1, v71
  v_fmac_f32 v17, v2, v71
  v_lshlrev_b32 v1, 16, v69
  v_and_b32 v2, 0xffff0000, v69
  v_fmac_f32 v18, v1, v71
  v_fmac_f32 v19, v2, v71
  v_lshlrev_b32 v1, 16, v70
  v_and_b32 v2, 0xffff0000, v70
  v_fmac_f32 v20, v1, v71
  v_fmac_f32 v21, v2, v71
  v_lshlrev_b32 v1, 16, v72
  v_and_b32 v2, 0xffff0000, v72
  v_fmac_f32 v16, v1, v75
  v_fmac_f32 v17, v2, v75
  v_lshlrev_b32 v1, 16, v73
  v_and_b32 v2, 0xffff0000, v73
  v_fmac_f32 v18, v1, v75
  v_fmac_f32 v19, v2, v75
  v_lshlrev_b32 v1, 16, v74
  v_and_b32 v2, 0xffff0000, v74
  v_fmac_f32 v20, v1, v75
  v_fmac_f32 v21, v2, v75
  v_lshlrev_b32 v1, 16, v76
  v_and_b32 v2, 0xffff0000, v76
  v_fmac_f32 v16, v1, v79
  v_fmac_f32 v17, v2, v79
  v_lshlrev_b32 v1, 16, v77
  v_and_b32 v2, 0xffff0000, v77
  v_fmac_f32 v18, v1, v79
  v_fmac_f32 v19, v2, v79
  v_lshlrev_b32 v1, 16, v78
  v_and_b32 v2, 0xffff0000, v78
  v_fmac_f32 v20, v1, v79
  v_fmac_f32 v21, v2, v79
  buffer_load_dwordx3 v[64:66], v13, s[40:43], s94 offen
  buffer_load_dwordx4 v[32:35], v9, s[28:31], s92 offen offset:0 nt
  buffer_load_dwordx4 v[36:39], v9, s[28:31], s92 offen offset:1024 nt
  buffer_load_dwordx4 v[40:43], v9, s[28:31], s92 offen offset:2048 nt
  buffer_load_dwordx4 v[44:47], v9, s[28:31], s93 offen offset:0 nt
  buffer_load_dwordx4 v[48:51], v9, s[28:31], s93 offen offset:1024 nt
  buffer_load_dwordx4 v[52:55], v9, s[28:31], s93 offen offset:2048 nt
  v_cvt_pk_bf16_f32 v1, v4, v4
  v_lshlrev_b32 v1, 16, v1
  v_mul_f32 v1, s87, v1
  v_cvt_pk_bf16_f32 v1, v1, v1
  v_lshlrev_b32 v1, 16, v1
  v_mul_f32 v27, s88, v1
  v_max_f32 v22, v24, v25
  v_max3_f32 v22, v22, v26, v27
  s_nop 1
  v_max_f32_dpp v22, v22, v22 row_ror:8 row_mask:0xf bank_mask:0xf
  s_nop 1
  v_max_f32_dpp v22, v22, v22 row_ror:4 row_mask:0xf bank_mask:0xf
  s_nop 1
  v_max_f32_dpp v22, v22, v22 row_ror:2 row_mask:0xf bank_mask:0xf
  s_nop 1
  v_max_f32_dpp v22, v22, v22 row_ror:1 row_mask:0xf bank_mask:0xf
  v_sub_f32 v24, v24, v22
  v_exp_f32 v24, v24
  v_sub_f32 v25, v25, v22
  v_exp_f32 v25, v25
  v_sub_f32 v26, v26, v22
  v_exp_f32 v26, v26
  v_sub_f32 v27, v27, v22
  v_exp_f32 v27, v27
  v_add_f32 v23, v24, v25
  v_add_f32 v1, v26, v27
  v_add_f32 v23, v23, v1
  v_mov_b32_dpp v1, v24 quad_perm:[1,0,3,2] row_mask:0xf bank_mask:0xf
  v_cvt_pk_bf16_f32 v28, v24, v1
  v_mov_b32_dpp v1, v25 quad_perm:[1,0,3,2] row_mask:0xf bank_mask:0xf
  v_cvt_pk_bf16_f32 v29, v25, v1
  v_mov_b32_dpp v1, v26 quad_perm:[1,0,3,2] row_mask:0xf bank_mask:0xf
  v_cvt_pk_bf16_f32 v30, v26, v1
  v_mov_b32_dpp v1, v27 quad_perm:[1,0,3,2] row_mask:0xf bank_mask:0xf
  v_cvt_pk_bf16_f32 v31, v27, v1
  v_add_f32_dpp v23, v23, v23 row_ror:8 row_mask:0xf bank_mask:0xf
  s_nop 1
  v_add_f32_dpp v23, v23, v23 row_ror:4 row_mask:0xf bank_mask:0xf
  s_nop 1
  v_add_f32_dpp v23, v23, v23 row_ror:2 row_mask:0xf bank_mask:0xf
  s_nop 1
  v_add_f32_dpp v23, v23, v23 row_ror:1 row_mask:0xf bank_mask:0xf
  ds_read_b32 v67, v14 offset:30736
  s_waitcnt vmcnt(6)
  s_waitcnt lgkmcnt(0)
  v_lshlrev_b32 v1, 16, v64
  v_and_b32 v2, 0xffff0000, v64
  v_fmac_f32 v16, v1, v67
  v_fmac_f32 v17, v2, v67
  v_lshlrev_b32 v1, 16, v65
  v_and_b32 v2, 0xffff0000, v65
  v_fmac_f32 v18, v1, v67
  v_fmac_f32 v19, v2, v67
  v_lshlrev_b32 v1, 16, v66
  v_and_b32 v2, 0xffff0000, v66
  v_fmac_f32 v20, v1, v67
  v_fmac_f32 v21, v2, v67
  v_add_f32_dpp v16, v16, v16 quad_perm:[1,0,3,2] row_mask:0xf bank_mask:0xf
  v_add_f32_dpp v17, v17, v17 quad_perm:[1,0,3,2] row_mask:0xf bank_mask:0xf
  v_add_f32_dpp v18, v18, v18 quad_perm:[1,0,3,2] row_mask:0xf bank_mask:0xf
  v_add_f32_dpp v19, v19, v19 quad_perm:[1,0,3,2] row_mask:0xf bank_mask:0xf
  v_add_f32_dpp v20, v20, v20 quad_perm:[1,0,3,2] row_mask:0xf bank_mask:0xf
  v_add_f32_dpp v21, v21, v21 quad_perm:[1,0,3,2] row_mask:0xf bank_mask:0xf
  v_add_f32_dpp v16, v16, v16 quad_perm:[2,3,0,1] row_mask:0xf bank_mask:0xf
  v_add_f32_dpp v17, v17, v17 quad_perm:[2,3,0,1] row_mask:0xf bank_mask:0xf
  v_add_f32_dpp v18, v18, v18 quad_perm:[2,3,0,1] row_mask:0xf bank_mask:0xf
  v_add_f32_dpp v19, v19, v19 quad_perm:[2,3,0,1] row_mask:0xf bank_mask:0xf
  v_add_f32_dpp v20, v20, v20 quad_perm:[2,3,0,1] row_mask:0xf bank_mask:0xf
  v_add_f32_dpp v21, v21, v21 quad_perm:[2,3,0,1] row_mask:0xf bank_mask:0xf
  v_add_f32_dpp v16, v16, v16 row_half_mirror row_mask:0xf bank_mask:0xf
  v_add_f32_dpp v17, v17, v17 row_half_mirror row_mask:0xf bank_mask:0xf
  v_add_f32_dpp v18, v18, v18 row_half_mirror row_mask:0xf bank_mask:0xf
  v_add_f32_dpp v19, v19, v19 row_half_mirror row_mask:0xf bank_mask:0xf
  v_add_f32_dpp v20, v20, v20 row_half_mirror row_mask:0xf bank_mask:0xf
  v_add_f32_dpp v21, v21, v21 row_half_mirror row_mask:0xf bank_mask:0xf
  v_lshrrev_b32 v1, 3, v0
  v_mul_u32_u24 v1, 24, v1
  s_mul_i32 s63, s60, 192
  v_add_u32 v1, s63, v1
  ds_write_b64 v1, v[16:17] offset:27648
  ds_write_b64 v1, v[18:19] offset:27656
  ds_write_b64 v1, v[20:21] offset:27664
  s_mul_i32 s63, s60, 15360
  v_lshlrev_b32 v1, 4, v0
  v_add_u32 v11, s63, v1
  v_lshlrev_b32 v1, 2, v0
  v_add_u32 v12, s63, v1
  v_add_u32 v12, 1024, v12
  s_mov_b32 s84, 0
  buffer_load_dwordx4 v[80:83], v11, s[44:47], s84 offen
  buffer_load_dword v96, v12, s[44:47], s84 offen
  s_mov_b32 s84, 1280
  buffer_load_dwordx4 v[84:87], v11, s[44:47], s84 offen
  buffer_load_dword v97, v12, s[44:47], s84 offen
  s_mov_b32 s84, 2560
  buffer_load_dwordx4 v[88:91], v11, s[44:47], s84 offen
  buffer_load_dword v98, v12, s[44:47], s84 offen
  s_mov_b32 s84, 3840
  buffer_load_dwordx4 v[92:95], v11, s[44:47], s84 offen
  buffer_load_dword v99, v12, s[44:47], s84 offen
  s_mov_b32 s84, 5120
  buffer_load_dwordx4 v[64:67], v11, s[44:47], s84 offen
  buffer_load_dword v76, v12, s[44:47], s84 offen
  s_mov_b32 s84, 6400
  buffer_load_dwordx4 v[68:71], v11, s[44:47], s84 offen
  buffer_load_dword v77, v12, s[44:47], s84 offen
  s_mov_b32 s84, 7680
  buffer_load_dwordx4 v[72:75], v11, s[44:47], s84 offen
  buffer_load_dword v78, v12, s[44:47], s84 offen
  v_mov_b32 v61, v22
  v_mov_b32 v62, v23
  ds_write_b128 v56, v[104:107] offset:0
  ds_write_b128 v57, v[108:111] offset:0
  ds_write_b128 v58, v[112:115] offset:0
  ds_write_b128 v56, v[116:119] offset:3200
  ds_write_b128 v57, v[120:123] offset:3200
  ds_write_b128 v58, v[124:127] offset:3200
  s_waitcnt lgkmcnt(0)
  ds_read_b128 v[104:107], v60 offset:0
  ds_read_b128 v[108:111], v60 offset:400
  ds_read_b128 v[112:115], v60 offset:800
  ds_read_b128 v[116:119], v60 offset:1200
  s_waitcnt lgkmcnt(0)
  v_mov_b32_dpp v3, v28 row_newbcast:0 row_mask:0x3 bank_mask:0xf
  s_nop 1
  v_mov_b32_dpp v3, v28 row_newbcast:8 row_mask:0xc bank_mask:0xf
  v_perm_b32 v4, v108, v104, s85
  v_perm_b32 v5, v108, v104, s86
  v_dot2_f32_bf16 v16, v4, v3, 0
  v_dot2_f32_bf16 v17, v5, v3, 0
  v_perm_b32 v6, v109, v105, s85
  v_perm_b32 v7, v109, v105, s86
  v_dot2_f32_bf16 v18, v6, v3, 0
  v_dot2_f32_bf16 v19, v7, v3, 0
  v_perm_b32 v4, v110, v106, s85
  v_perm_b32 v5, v110, v106, s86
  v_dot2_f32_bf16 v20, v4, v3, 0
  v_dot2_f32_bf16 v21, v5, v3, 0
  v_perm_b32 v6, v111, v107, s85
  v_perm_b32 v7, v111, v107, s86
  v_dot2_f32_bf16 v22, v6, v3, 0
  v_dot2_f32_bf16 v23, v7, v3, 0
  v_mov_b32_dpp v3, v28 row_newbcast:2 row_mask:0x3 bank_mask:0xf
  s_nop 1
  v_mov_b32_dpp v3, v28 row_newbcast:10 row_mask:0xc bank_mask:0xf
  v_perm_b32 v4, v116, v112, s85
  v_perm_b32 v5, v116, v112, s86
  v_dot2_f32_bf16 v16, v4, v3, v16
  v_dot2_f32_bf16 v17, v5, v3, v17
  v_perm_b32 v6, v117, v113, s85
  v_perm_b32 v7, v117, v113, s86
  v_dot2_f32_bf16 v18, v6, v3, v18
  v_dot2_f32_bf16 v19, v7, v3, v19
  v_perm_b32 v4, v118, v114, s85
  v_perm_b32 v5, v118, v114, s86
  v_dot2_f32_bf16 v20, v4, v3, v20
  v_dot2_f32_bf16 v21, v5, v3, v21
  v_perm_b32 v6, v119, v115, s85
  v_perm_b32 v7, v119, v115, s86
  v_dot2_f32_bf16 v22, v6, v3, v22
  v_dot2_f32_bf16 v23, v7, v3, v23
  ds_read_b128 v[104:107], v60 offset:1600
  ds_read_b128 v[108:111], v60 offset:2000
  ds_read_b128 v[112:115], v60 offset:2400
  ds_read_b128 v[116:119], v60 offset:2800
  s_waitcnt lgkmcnt(0)
  v_mov_b32_dpp v3, v28 row_newbcast:4 row_mask:0x3 bank_mask:0xf
  s_nop 1
  v_mov_b32_dpp v3, v28 row_newbcast:12 row_mask:0xc bank_mask:0xf
  v_perm_b32 v4, v108, v104, s85
  v_perm_b32 v5, v108, v104, s86
  v_dot2_f32_bf16 v16, v4, v3, v16
  v_dot2_f32_bf16 v17, v5, v3, v17
  v_perm_b32 v6, v109, v105, s85
  v_perm_b32 v7, v109, v105, s86
  v_dot2_f32_bf16 v18, v6, v3, v18
  v_dot2_f32_bf16 v19, v7, v3, v19
  v_perm_b32 v4, v110, v106, s85
  v_perm_b32 v5, v110, v106, s86
  v_dot2_f32_bf16 v20, v4, v3, v20
  v_dot2_f32_bf16 v21, v5, v3, v21
  v_perm_b32 v6, v111, v107, s85
  v_perm_b32 v7, v111, v107, s86
  v_dot2_f32_bf16 v22, v6, v3, v22
  v_dot2_f32_bf16 v23, v7, v3, v23
  v_mov_b32_dpp v3, v28 row_newbcast:6 row_mask:0x3 bank_mask:0xf
  s_nop 1
  v_mov_b32_dpp v3, v28 row_newbcast:14 row_mask:0xc bank_mask:0xf
  v_perm_b32 v4, v116, v112, s85
  v_perm_b32 v5, v116, v112, s86
  v_dot2_f32_bf16 v16, v4, v3, v16
  v_dot2_f32_bf16 v17, v5, v3, v17
  v_perm_b32 v6, v117, v113, s85
  v_perm_b32 v7, v117, v113, s86
  v_dot2_f32_bf16 v18, v6, v3, v18
  v_dot2_f32_bf16 v19, v7, v3, v19
  v_perm_b32 v4, v118, v114, s85
  v_perm_b32 v5, v118, v114, s86
  v_dot2_f32_bf16 v20, v4, v3, v20
  v_dot2_f32_bf16 v21, v5, v3, v21
  v_perm_b32 v6, v119, v115, s85
  v_perm_b32 v7, v119, v115, s86
  v_dot2_f32_bf16 v22, v6, v3, v22
  v_dot2_f32_bf16 v23, v7, v3, v23
  buffer_load_dwordx4 v[104:107], v9, s[28:31], s94 offen offset:0 nt
  buffer_load_dwordx4 v[108:111], v9, s[28:31], s94 offen offset:1024 nt
  buffer_load_dwordx4 v[112:115], v9, s[28:31], s94 offen offset:2048 nt
  buffer_load_dwordx4 v[116:119], v9, s[28:31], s95 offen offset:0 nt
  buffer_load_dwordx4 v[120:123], v9, s[28:31], s95 offen offset:1024 nt
  buffer_load_dwordx4 v[124:127], v9, s[28:31], s95 offen offset:2048 nt
  s_waitcnt vmcnt(20)
  ds_write_b128 v56, v[32:35] offset:0
  ds_write_b128 v57, v[36:39] offset:0
  ds_write_b128 v58, v[40:43] offset:0
  ds_write_b128 v56, v[44:47] offset:3200
  ds_write_b128 v57, v[48:51] offset:3200
  ds_write_b128 v58, v[52:55] offset:3200
  s_waitcnt lgkmcnt(0)
  ds_read_b128 v[32:35], v60 offset:0
  ds_read_b128 v[36:39], v60 offset:400
  ds_read_b128 v[40:43], v60 offset:800
  ds_read_b128 v[44:47], v60 offset:1200
  s_waitcnt lgkmcnt(0)
  v_mov_b32_dpp v3, v29 row_newbcast:0 row_mask:0x3 bank_mask:0xf
  s_nop 1
  v_mov_b32_dpp v3, v29 row_newbcast:8 row_mask:0xc bank_mask:0xf
  v_perm_b32 v4, v36, v32, s85
  v_perm_b32 v5, v36, v32, s86
  v_dot2_f32_bf16 v16, v4, v3, v16
  v_dot2_f32_bf16 v17, v5, v3, v17
  v_perm_b32 v6, v37, v33, s85
  v_perm_b32 v7, v37, v33, s86
  v_dot2_f32_bf16 v18, v6, v3, v18
  v_dot2_f32_bf16 v19, v7, v3, v19
  v_perm_b32 v4, v38, v34, s85
  v_perm_b32 v5, v38, v34, s86
  v_dot2_f32_bf16 v20, v4, v3, v20
  v_dot2_f32_bf16 v21, v5, v3, v21
  v_perm_b32 v6, v39, v35, s85
  v_perm_b32 v7, v39, v35, s86
  v_dot2_f32_bf16 v22, v6, v3, v22
  v_dot2_f32_bf16 v23, v7, v3, v23
  v_mov_b32_dpp v3, v29 row_newbcast:2 row_mask:0x3 bank_mask:0xf
  s_nop 1
  v_mov_b32_dpp v3, v29 row_newbcast:10 row_mask:0xc bank_mask:0xf
  v_perm_b32 v4, v44, v40, s85
  v_perm_b32 v5, v44, v40, s86
  v_dot2_f32_bf16 v16, v4, v3, v16
  v_dot2_f32_bf16 v17, v5, v3, v17
  v_perm_b32 v6, v45, v41, s85
  v_perm_b32 v7, v45, v41, s86
  v_dot2_f32_bf16 v18, v6, v3, v18
  v_dot2_f32_bf16 v19, v7, v3, v19
  v_perm_b32 v4, v46, v42, s85
  v_perm_b32 v5, v46, v42, s86
  v_dot2_f32_bf16 v20, v4, v3, v20
  v_dot2_f32_bf16 v21, v5, v3, v21
  v_perm_b32 v6, v47, v43, s85
  v_perm_b32 v7, v47, v43, s86
  v_dot2_f32_bf16 v22, v6, v3, v22
  v_dot2_f32_bf16 v23, v7, v3, v23
  ds_read_b128 v[32:35], v60 offset:1600
  ds_read_b128 v[36:39], v60 offset:2000
  ds_read_b128 v[40:43], v60 offset:2400
  ds_read_b128 v[44:47], v60 offset:2800
  s_waitcnt lgkmcnt(0)
  v_mov_b32_dpp v3, v29 row_newbcast:4 row_mask:0x3 bank_mask:0xf
  s_nop 1
  v_mov_b32_dpp v3, v29 row_newbcast:12 row_mask:0xc bank_mask:0xf
  v_perm_b32 v4, v36, v32, s85
  v_perm_b32 v5, v36, v32, s86
  v_dot2_f32_bf16 v16, v4, v3, v16
  v_dot2_f32_bf16 v17, v5, v3, v17
  v_perm_b32 v6, v37, v33, s85
  v_perm_b32 v7, v37, v33, s86
  v_dot2_f32_bf16 v18, v6, v3, v18
  v_dot2_f32_bf16 v19, v7, v3, v19
  v_perm_b32 v4, v38, v34, s85
  v_perm_b32 v5, v38, v34, s86
  v_dot2_f32_bf16 v20, v4, v3, v20
  v_dot2_f32_bf16 v21, v5, v3, v21
  v_perm_b32 v6, v39, v35, s85
  v_perm_b32 v7, v39, v35, s86
  v_dot2_f32_bf16 v22, v6, v3, v22
  v_dot2_f32_bf16 v23, v7, v3, v23
  v_mov_b32_dpp v3, v29 row_newbcast:6 row_mask:0x3 bank_mask:0xf
  s_nop 1
  v_mov_b32_dpp v3, v29 row_newbcast:14 row_mask:0xc bank_mask:0xf
  v_perm_b32 v4, v44, v40, s85
  v_perm_b32 v5, v44, v40, s86
  v_dot2_f32_bf16 v16, v4, v3, v16
  v_dot2_f32_bf16 v17, v5, v3, v17
  v_perm_b32 v6, v45, v41, s85
  v_perm_b32 v7, v45, v41, s86
  v_dot2_f32_bf16 v18, v6, v3, v18
  v_dot2_f32_bf16 v19, v7, v3, v19
  v_perm_b32 v4, v46, v42, s85
  v_perm_b32 v5, v46, v42, s86
  v_dot2_f32_bf16 v20, v4, v3, v20
  v_dot2_f32_bf16 v21, v5, v3, v21
  v_perm_b32 v6, v47, v43, s85
  v_perm_b32 v7, v47, v43, s86
  v_dot2_f32_bf16 v22, v6, v3, v22
  v_dot2_f32_bf16 v23, v7, v3, v23
  buffer_load_dwordx4 v[32:35], v9, s[28:31], s96 offen offset:0 nt
  buffer_load_dwordx4 v[36:39], v9, s[28:31], s96 offen offset:1024 nt
  buffer_load_dwordx4 v[40:43], v9, s[28:31], s96 offen offset:2048 nt
  buffer_load_dwordx4 v[44:47], v9, s[28:31], s97 offen offset:0 nt
  buffer_load_dwordx4 v[48:51], v9, s[28:31], s97 offen offset:1024 nt
  buffer_load_dwordx4 v[52:55], v9, s[28:31], s97 offen offset:2048 nt
  s_waitcnt vmcnt(6)
  ds_write_b128 v56, v[104:107] offset:0
  ds_write_b128 v57, v[108:111] offset:0
  ds_write_b128 v58, v[112:115] offset:0
  ds_write_b128 v56, v[116:119] offset:3200
  ds_write_b128 v57, v[120:123] offset:3200
  ds_write_b128 v58, v[124:127] offset:3200
  s_waitcnt lgkmcnt(0)
  ds_read_b128 v[104:107], v60 offset:0
  ds_read_b128 v[108:111], v60 offset:400
  ds_read_b128 v[112:115], v60 offset:800
  ds_read_b128 v[116:119], v60 offset:1200
  s_waitcnt lgkmcnt(0)
  v_mov_b32_dpp v3, v30 row_newbcast:0 row_mask:0x3 bank_mask:0xf
  s_nop 1
  v_mov_b32_dpp v3, v30 row_newbcast:8 row_mask:0xc bank_mask:0xf
  v_perm_b32 v4, v108, v104, s85
  v_perm_b32 v5, v108, v104, s86
  v_dot2_f32_bf16 v16, v4, v3, v16
  v_dot2_f32_bf16 v17, v5, v3, v17
  v_perm_b32 v6, v109, v105, s85
  v_perm_b32 v7, v109, v105, s86
  v_dot2_f32_bf16 v18, v6, v3, v18
  v_dot2_f32_bf16 v19, v7, v3, v19
  v_perm_b32 v4, v110, v106, s85
  v_perm_b32 v5, v110, v106, s86
  v_dot2_f32_bf16 v20, v4, v3, v20
  v_dot2_f32_bf16 v21, v5, v3, v21
  v_perm_b32 v6, v111, v107, s85
  v_perm_b32 v7, v111, v107, s86
  v_dot2_f32_bf16 v22, v6, v3, v22
  v_dot2_f32_bf16 v23, v7, v3, v23
  v_mov_b32_dpp v3, v30 row_newbcast:2 row_mask:0x3 bank_mask:0xf
  s_nop 1
  v_mov_b32_dpp v3, v30 row_newbcast:10 row_mask:0xc bank_mask:0xf
  v_perm_b32 v4, v116, v112, s85
  v_perm_b32 v5, v116, v112, s86
  v_dot2_f32_bf16 v16, v4, v3, v16
  v_dot2_f32_bf16 v17, v5, v3, v17
  v_perm_b32 v6, v117, v113, s85
  v_perm_b32 v7, v117, v113, s86
  v_dot2_f32_bf16 v18, v6, v3, v18
  v_dot2_f32_bf16 v19, v7, v3, v19
  v_perm_b32 v4, v118, v114, s85
  v_perm_b32 v5, v118, v114, s86
  v_dot2_f32_bf16 v20, v4, v3, v20
  v_dot2_f32_bf16 v21, v5, v3, v21
  v_perm_b32 v6, v119, v115, s85
  v_perm_b32 v7, v119, v115, s86
  v_dot2_f32_bf16 v22, v6, v3, v22
  v_dot2_f32_bf16 v23, v7, v3, v23
  ds_read_b128 v[104:107], v60 offset:1600
  ds_read_b128 v[108:111], v60 offset:2000
  ds_read_b128 v[112:115], v60 offset:2400
  ds_read_b128 v[116:119], v60 offset:2800
  s_waitcnt lgkmcnt(0)
  v_mov_b32_dpp v3, v30 row_newbcast:4 row_mask:0x3 bank_mask:0xf
  s_nop 1
  v_mov_b32_dpp v3, v30 row_newbcast:12 row_mask:0xc bank_mask:0xf
  v_perm_b32 v4, v108, v104, s85
  v_perm_b32 v5, v108, v104, s86
  v_dot2_f32_bf16 v16, v4, v3, v16
  v_dot2_f32_bf16 v17, v5, v3, v17
  v_perm_b32 v6, v109, v105, s85
  v_perm_b32 v7, v109, v105, s86
  v_dot2_f32_bf16 v18, v6, v3, v18
  v_dot2_f32_bf16 v19, v7, v3, v19
  v_perm_b32 v4, v110, v106, s85
  v_perm_b32 v5, v110, v106, s86
  v_dot2_f32_bf16 v20, v4, v3, v20
  v_dot2_f32_bf16 v21, v5, v3, v21
  v_perm_b32 v6, v111, v107, s85
  v_perm_b32 v7, v111, v107, s86
  v_dot2_f32_bf16 v22, v6, v3, v22
  v_dot2_f32_bf16 v23, v7, v3, v23
  v_mov_b32_dpp v3, v30 row_newbcast:6 row_mask:0x3 bank_mask:0xf
  s_nop 1
  v_mov_b32_dpp v3, v30 row_newbcast:14 row_mask:0xc bank_mask:0xf
  v_perm_b32 v4, v116, v112, s85
  v_perm_b32 v5, v116, v112, s86
  v_dot2_f32_bf16 v16, v4, v3, v16
  v_dot2_f32_bf16 v17, v5, v3, v17
  v_perm_b32 v6, v117, v113, s85
  v_perm_b32 v7, v117, v113, s86
  v_dot2_f32_bf16 v18, v6, v3, v18
  v_dot2_f32_bf16 v19, v7, v3, v19
  v_perm_b32 v4, v118, v114, s85
  v_perm_b32 v5, v118, v114, s86
  v_dot2_f32_bf16 v20, v4, v3, v20
  v_dot2_f32_bf16 v21, v5, v3, v21
  v_perm_b32 v6, v119, v115, s85
  v_perm_b32 v7, v119, v115, s86
  v_dot2_f32_bf16 v22, v6, v3, v22
  v_dot2_f32_bf16 v23, v7, v3, v23
  s_mov_b32 s84, 8960
  buffer_load_dwordx4 v[104:107], v11, s[44:47], s84 offen
  buffer_load_dword v120, v12, s[44:47], s84 offen
  s_mov_b32 s84, 10240
  buffer_load_dwordx4 v[108:111], v11, s[44:47], s84 offen
  buffer_load_dword v121, v12, s[44:47], s84 offen
  s_mov_b32 s84, 11520
  buffer_load_dwordx4 v[112:115], v11, s[44:47], s84 offen
  buffer_load_dword v122, v12, s[44:47], s84 offen
  s_mov_b32 s84, 12800
  buffer_load_dwordx4 v[116:119], v11, s[44:47], s84 offen
  buffer_load_dword v123, v12, s[44:47], s84 offen
  s_waitcnt vmcnt(8)
  ds_write_b128 v56, v[32:35] offset:0
  ds_write_b128 v57, v[36:39] offset:0
  ds_write_b128 v58, v[40:43] offset:0
  ds_write_b128 v56, v[44:47] offset:3200
  ds_write_b128 v57, v[48:51] offset:3200
  ds_write_b128 v58, v[52:55] offset:3200
  s_waitcnt lgkmcnt(0)
  ds_read_b128 v[32:35], v60 offset:0
  ds_read_b128 v[36:39], v60 offset:400
  ds_read_b128 v[40:43], v60 offset:800
  ds_read_b128 v[44:47], v60 offset:1200
  s_waitcnt lgkmcnt(0)
  v_mov_b32_dpp v3, v31 row_newbcast:0 row_mask:0x3 bank_mask:0xf
  s_nop 1
  v_mov_b32_dpp v3, v31 row_newbcast:8 row_mask:0xc bank_mask:0xf
  v_perm_b32 v4, v36, v32, s85
  v_perm_b32 v5, v36, v32, s86
  v_dot2_f32_bf16 v16, v4, v3, v16
  v_dot2_f32_bf16 v17, v5, v3, v17
  v_perm_b32 v6, v37, v33, s85
  v_perm_b32 v7, v37, v33, s86
  v_dot2_f32_bf16 v18, v6, v3, v18
  v_dot2_f32_bf16 v19, v7, v3, v19
  v_perm_b32 v4, v38, v34, s85
  v_perm_b32 v5, v38, v34, s86
  v_dot2_f32_bf16 v20, v4, v3, v20
  v_dot2_f32_bf16 v21, v5, v3, v21
  v_perm_b32 v6, v39, v35, s85
  v_perm_b32 v7, v39, v35, s86
  v_dot2_f32_bf16 v22, v6, v3, v22
  v_dot2_f32_bf16 v23, v7, v3, v23
  v_mov_b32_dpp v3, v31 row_newbcast:2 row_mask:0x3 bank_mask:0xf
  s_nop 1
  v_mov_b32_dpp v3, v31 row_newbcast:10 row_mask:0xc bank_mask:0xf
  v_perm_b32 v4, v44, v40, s85
  v_perm_b32 v5, v44, v40, s86
  v_dot2_f32_bf16 v16, v4, v3, v16
  v_dot2_f32_bf16 v17, v5, v3, v17
  v_perm_b32 v6, v45, v41, s85
  v_perm_b32 v7, v45, v41, s86
  v_dot2_f32_bf16 v18, v6, v3, v18
  v_dot2_f32_bf16 v19, v7, v3, v19
  v_perm_b32 v4, v46, v42, s85
  v_perm_b32 v5, v46, v42, s86
  v_dot2_f32_bf16 v20, v4, v3, v20
  v_dot2_f32_bf16 v21, v5, v3, v21
  v_perm_b32 v6, v47, v43, s85
  v_perm_b32 v7, v47, v43, s86
  v_dot2_f32_bf16 v22, v6, v3, v22
  v_dot2_f32_bf16 v23, v7, v3, v23
  ds_read_b128 v[32:35], v60 offset:1600
  ds_read_b128 v[36:39], v60 offset:2000
  ds_read_b128 v[40:43], v60 offset:2400
  ds_read_b128 v[44:47], v60 offset:2800
  s_waitcnt lgkmcnt(0)
  v_mov_b32_dpp v3, v31 row_newbcast:4 row_mask:0x3 bank_mask:0xf
  s_nop 1
  v_mov_b32_dpp v3, v31 row_newbcast:12 row_mask:0xc bank_mask:0xf
  v_perm_b32 v4, v36, v32, s85
  v_perm_b32 v5, v36, v32, s86
  v_dot2_f32_bf16 v16, v4, v3, v16
  v_dot2_f32_bf16 v17, v5, v3, v17
  v_perm_b32 v6, v37, v33, s85
  v_perm_b32 v7, v37, v33, s86
  v_dot2_f32_bf16 v18, v6, v3, v18
  v_dot2_f32_bf16 v19, v7, v3, v19
  v_perm_b32 v4, v38, v34, s85
  v_perm_b32 v5, v38, v34, s86
  v_dot2_f32_bf16 v20, v4, v3, v20
  v_dot2_f32_bf16 v21, v5, v3, v21
  v_perm_b32 v6, v39, v35, s85
  v_perm_b32 v7, v39, v35, s86
  v_dot2_f32_bf16 v22, v6, v3, v22
  v_dot2_f32_bf16 v23, v7, v3, v23
  v_mov_b32_dpp v3, v31 row_newbcast:6 row_mask:0x3 bank_mask:0xf
  s_nop 1
  v_mov_b32_dpp v3, v31 row_newbcast:14 row_mask:0xc bank_mask:0xf
  v_perm_b32 v4, v44, v40, s85
  v_perm_b32 v5, v44, v40, s86
  v_dot2_f32_bf16 v16, v4, v3, v16
  v_dot2_f32_bf16 v17, v5, v3, v17
  v_perm_b32 v6, v45, v41, s85
  v_perm_b32 v7, v45, v41, s86
  v_dot2_f32_bf16 v18, v6, v3, v18
  v_dot2_f32_bf16 v19, v7, v3, v19
  v_perm_b32 v4, v46, v42, s85
  v_perm_b32 v5, v46, v42, s86
  v_dot2_f32_bf16 v20, v4, v3, v20
  v_dot2_f32_bf16 v21, v5, v3, v21
  v_perm_b32 v6, v47, v43, s85
  v_perm_b32 v7, v47, v43, s86
  v_dot2_f32_bf16 v22, v6, v3, v22
  v_dot2_f32_bf16 v23, v7, v3, v23
  s_mov_b32 s84, 14080
  buffer_load_dwordx4 v[32:35], v11, s[44:47], s84 offen
  buffer_load_dword v48, v12, s[44:47], s84 offen
  s_mul_i32 s63, s60, 3840
  v_lshlrev_b32 v1, 4, v0
  v_add_u32 v1, s63, v1
  v_lshlrev_b32 v2, 2, v0
  v_add_u32 v2, s63, v2
  buffer_load_dwordx4 v[36:39], v1, s[48:51], 0 offen offset:0
  buffer_load_dword v49, v2, s[48:51], 0 offen offset:1024
  buffer_load_dwordx4 v[40:43], v1, s[48:51], 0 offen offset:1280
  buffer_load_dword v50, v2, s[48:51], 0 offen offset:2304
  buffer_load_dwordx4 v[44:47], v1, s[48:51], 0 offen offset:2560
  buffer_load_dword v51, v2, s[48:51], 0 offen offset:3584
  v_and_b32 v1, 31, v0
  v_min_u32 v1, 23, v1
  v_lshlrev_b32 v1, 5, v1
  v_lshrrev_b32 v2, 5, v0
  v_mul_u32_u24 v2, 768, v2
  v_add_u32 v1, v1, v2
  s_mul_i32 s63, s60, 1536
  v_add_u32 v1, s63, v1
  v_and_b32 v2, 31, v0
  v_cmp_gt_u32 vcc, 24, v2
  s_and_saveexec_b64 s[98:99], vcc
  ds_write_b128 v1, v[16:19] offset:0
  ds_write_b128 v1, v[20:23] offset:16
  s_mov_b64 exec, s[98:99]
  s_lshl_b32 s63, s60, 3
  v_mov_b32 v1, s63
  v_mov_b32 v2, v61
  v_mov_b32 v3, v62
  ds_write_b64 v1, v[2:3] offset:35584
  s_waitcnt lgkmcnt(0)
  s_barrier
  s_cmp_ge_u32 s60, 3
  s_cbranch_scc1 L_a_fino_skip
  v_and_b32 v1, 15, v0
  v_lshlrev_b32 v1, 3, v1
  ds_read_b64 v[2:3], v1 offset:35584
  s_waitcnt lgkmcnt(0)
  v_mov_b32 v4, v2
  s_nop 1
  v_max_f32_dpp v4, v4, v4 row_ror:8 row_mask:0xf bank_mask:0xf
  s_nop 1
  v_max_f32_dpp v4, v4, v4 row_ror:4 row_mask:0xf bank_mask:0xf
  s_nop 1
  v_max_f32_dpp v4, v4, v4 row_ror:2 row_mask:0xf bank_mask:0xf
  s_nop 1
  v_max_f32_dpp v4, v4, v4 row_ror:1 row_mask:0xf bank_mask:0xf
  v_sub_f32 v2, v2, v4
  v_exp_f32 v2, v2
  s_nop 0
  v_mul_f32 v3, v2, v3
  s_nop 1
  v_add_f32_dpp v3, v3, v3 row_ror:8 row_mask:0xf bank_mask:0xf
  s_nop 1
  v_add_f32_dpp v3, v3, v3 row_ror:4 row_mask:0xf bank_mask:0xf
  s_nop 1
  v_add_f32_dpp v3, v3, v3 row_ror:2 row_mask:0xf bank_mask:0xf
  s_nop 1
  v_add_f32_dpp v3, v3, v3 row_ror:1 row_mask:0xf bank_mask:0xf
  v_rcp_f32 v3, v3
  s_nop 0
  v_mul_f32 v2, v2, v3
  s_nop 0
  v_readlane_b32 s64, v2, 0
  v_readlane_b32 s65, v2, 1
  v_readlane_b32 s66, v2, 2
  v_readlane_b32 s67, v2, 3
  v_readlane_b32 s68, v2, 4
  v_readlane_b32 s69, v2, 5
  v_readlane_b32 s70, v2, 6
  v_readlane_b32 s71, v2, 7
  v_readlane_b32 s72, v2, 8
  v_readlane_b32 s73, v2, 9
  v_readlane_b32 s74, v2, 10
  v_readlane_b32 s75, v2, 11
  v_readlane_b32 s76, v2, 12
  v_readlane_b32 s77, v2, 13
  v_readlane_b32 s78, v2, 14
  v_readlane_b32 s79, v2, 15
  s_lshl_b32 s63, s60, 8
  v_lshlrev_b32 v1, 2, v0
  v_add_u32 v1, s63, v1
  v_mov_b32 v4, 0
  ds_read_b32 v16, v1 offset:0
  ds_read_b32 v17, v1 offset:1536
  ds_read_b32 v18, v1 offset:3072
  ds_read_b32 v19, v1 offset:4608
  ds_read_b32 v20, v1 offset:6144
  ds_read_b32 v21, v1 offset:7680
  ds_read_b32 v22, v1 offset:9216
  ds_read_b32 v23, v1 offset:10752
  ds_read_b32 v24, v1 offset:12288
  ds_read_b32 v25, v1 offset:13824
  ds_read_b32 v26, v1 offset:15360
  ds_read_b32 v27, v1 offset:16896
  ds_read_b32 v28, v1 offset:18432
  ds_read_b32 v29, v1 offset:19968
  ds_read_b32 v30, v1 offset:21504
  ds_read_b32 v31, v1 offset:23040
  s_waitcnt lgkmcnt(0)
  v_fmac_f32 v4, s64, v16
  v_fmac_f32 v4, s65, v17
  v_fmac_f32 v4, s66, v18
  v_fmac_f32 v4, s67, v19
  v_fmac_f32 v4, s68, v20
  v_fmac_f32 v4, s69, v21
  v_fmac_f32 v4, s70, v22
  v_fmac_f32 v4, s71, v23
  v_fmac_f32 v4, s72, v24
  v_fmac_f32 v4, s73, v25
  v_fmac_f32 v4, s74, v26
  v_fmac_f32 v4, s75, v27
  v_fmac_f32 v4, s76, v28
  v_fmac_f32 v4, s77, v29
  v_fmac_f32 v4, s78, v30
  v_fmac_f32 v4, s79, v31
  ds_read_b32 v16, v1 offset:768
  ds_read_b32 v17, v1 offset:2304
  ds_read_b32 v18, v1 offset:3840
  ds_read_b32 v19, v1 offset:5376
  ds_read_b32 v20, v1 offset:6912
  ds_read_b32 v21, v1 offset:8448
  ds_read_b32 v22, v1 offset:9984
  ds_read_b32 v23, v1 offset:11520
  ds_read_b32 v24, v1 offset:13056
  ds_read_b32 v25, v1 offset:14592
  ds_read_b32 v26, v1 offset:16128
  ds_read_b32 v27, v1 offset:17664
  ds_read_b32 v28, v1 offset:19200
  ds_read_b32 v29, v1 offset:20736
  ds_read_b32 v30, v1 offset:22272
  ds_read_b32 v31, v1 offset:23808
  s_waitcnt lgkmcnt(0)
  v_fmac_f32 v4, s64, v16
  v_fmac_f32 v4, s65, v17
  v_fmac_f32 v4, s66, v18
  v_fmac_f32 v4, s67, v19
  v_fmac_f32 v4, s68, v20
  v_fmac_f32 v4, s69, v21
  v_fmac_f32 v4, s70, v22
  v_fmac_f32 v4, s71, v23
  v_fmac_f32 v4, s72, v24
  v_fmac_f32 v4, s73, v25
  v_fmac_f32 v4, s74, v26
  v_fmac_f32 v4, s75, v27
  v_fmac_f32 v4, s76, v28
  v_fmac_f32 v4, s77, v29
  v_fmac_f32 v4, s78, v30
  v_fmac_f32 v4, s79, v31
  v_cvt_pk_bf16_f32 v4, v4, v4
  v_lshrrev_b32 v1, 1, v1
  ds_write_b16 v1, v4 offset:35840
  s_branch L_a_fino_done
L_a_fino_skip:
  s_cmp_lg_u32 s60, 3
  s_cbranch_scc1 L_a_fino_done
  v_min_u32 v1, 47, v0
  v_lshlrev_b32 v1, 2, v1
  v_mov_b32 v2, 0
  v_mov_b32 v3, 0
  ds_read_b32 v16, v1 offset:24576
  ds_read_b32 v24, v1 offset:27648
  ds_read_b32 v17, v1 offset:24768
  ds_read_b32 v25, v1 offset:27840
  ds_read_b32 v18, v1 offset:24960
  ds_read_b32 v26, v1 offset:28032
  ds_read_b32 v19, v1 offset:25152
  ds_read_b32 v27, v1 offset:28224
  ds_read_b32 v20, v1 offset:25344
  ds_read_b32 v28, v1 offset:28416
  ds_read_b32 v21, v1 offset:25536
  ds_read_b32 v29, v1 offset:28608
  ds_read_b32 v22, v1 offset:25728
  ds_read_b32 v30, v1 offset:28800
  ds_read_b32 v23, v1 offset:25920
  ds_read_b32 v31, v1 offset:28992
  s_waitcnt lgkmcnt(0)
  v_add_f32 v2, v2, v16
  v_add_f32 v3, v3, v24
  v_add_f32 v2, v2, v17
  v_add_f32 v3, v3, v25
  v_add_f32 v2, v2, v18
  v_add_f32 v3, v3, v26
  v_add_f32 v2, v2, v19
  v_add_f32 v3, v3, v27
  v_add_f32 v2, v2, v20
  v_add_f32 v3, v3, v28
  v_add_f32 v2, v2, v21
  v_add_f32 v3, v3, v29
  v_add_f32 v2, v2, v22
  v_add_f32 v3, v3, v30
  v_add_f32 v2, v2, v23
  v_add_f32 v3, v3, v31
  ds_read_b32 v16, v1 offset:26112
  ds_read_b32 v24, v1 offset:29184
  ds_read_b32 v17, v1 offset:26304
  ds_read_b32 v25, v1 offset:29376
  ds_read_b32 v18, v1 offset:26496
  ds_read_b32 v26, v1 offset:29568
  ds_read_b32 v19, v1 offset:26688
  ds_read_b32 v27, v1 offset:29760
  ds_read_b32 v20, v1 offset:26880
  ds_read_b32 v28, v1 offset:29952
  ds_read_b32 v21, v1 offset:27072
  ds_read_b32 v29, v1 offset:30144
  ds_read_b32 v22, v1 offset:27264
  ds_read_b32 v30, v1 offset:30336
  ds_read_b32 v23, v1 offset:27456
  ds_read_b32 v31, v1 offset:30528
  s_waitcnt lgkmcnt(0)
  v_add_f32 v2, v2, v16
  v_add_f32 v3, v3, v24
  v_add_f32 v2, v2, v17
  v_add_f32 v3, v3, v25
  v_add_f32 v2, v2, v18
  v_add_f32 v3, v3, v26
  v_add_f32 v2, v2, v19
  v_add_f32 v3, v3, v27
  v_add_f32 v2, v2, v20
  v_add_f32 v3, v3, v28
  v_add_f32 v2, v2, v21
  v_add_f32 v3, v3, v29
  v_add_f32 v2, v2, v22
  v_add_f32 v3, v3, v30
  v_add_f32 v2, v2, v23
  v_add_f32 v3, v3, v31
  v_cvt_pk_bf16_f32 v2, v2, v2
  v_lshlrev_b32 v2, 16, v2
  v_cvt_pk_bf16_f32 v3, v3, v3
  v_lshlrev_b32 v3, 16, v3
  v_mul_f32 v4, v2, v2
  v_mov_b32 v5, 0x3d372713
  v_fma_f32 v4, v4, v5, 1.0
  v_mul_f32 v4, v4, v2
  v_mul_f32 v4, 0x40135761, v4
  v_exp_f32 v4, v4
  s_nop 0
  v_add_f32 v4, 1.0, v4
  v_rcp_f32 v4, v4
  s_nop 0
  v_fma_f32 v4, v4, -2.0, 1.0
  v_add_f32 v4, 1.0, v4
  v_mul_f32 v4, 0.5, v4
  v_mul_f32 v4, v4, v2
  v_cvt_pk_bf16_f32 v4, v4, v4
  v_lshlrev_b32 v4, 16, v4
  v_mul_f32 v4, v4, v3
  v_cvt_pk_bf16_f32 v4, v4, v4
  v_lshlrev_b32 v4, 16, v4
  ds_write_b32 v1, v4 offset:35328
L_a_fino_done:
  s_nop 4
  s_waitcnt lgkmcnt(0)
  s_barrier
  s_mul_i32 s63, s60, 24
  v_mov_b32 v1, s63
  ds_read_b32 v26, v1 offset:35840
  ds_read_b32 v27, v1 offset:35844
  ds_read_b32 v28, v1 offset:35848
  ds_read_b32 v29, v1 offset:35852
  ds_read_b32 v30, v1 offset:35856
  ds_read_b32 v31, v1 offset:35860
  s_waitcnt vmcnt(6)
  s_waitcnt lgkmcnt(0)
  v_perm_b32 v4, v84, v80, s85
  v_perm_b32 v5, v84, v80, s86
  v_dot2_f32_bf16 v16, v4, v26, 0
  v_dot2_f32_bf16 v17, v5, v26, 0
  v_perm_b32 v6, v85, v81, s85
  v_perm_b32 v7, v85, v81, s86
  v_dot2_f32_bf16 v18, v6, v26, 0
  v_dot2_f32_bf16 v19, v7, v26, 0
  v_perm_b32 v4, v86, v82, s85
  v_perm_b32 v5, v86, v82, s86
  v_dot2_f32_bf16 v20, v4, v26, 0
  v_dot2_f32_bf16 v21, v5, v26, 0
  v_perm_b32 v6, v87, v83, s85
  v_perm_b32 v7, v87, v83, s86
  v_dot2_f32_bf16 v22, v6, v26, 0
  v_dot2_f32_bf16 v23, v7, v26, 0
  v_perm_b32 v4, v97, v96, s85
  v_perm_b32 v5, v97, v96, s86
  v_dot2_f32_bf16 v24, v4, v26, 0
  v_dot2_f32_bf16 v25, v5, v26, 0
  v_perm_b32 v4, v92, v88, s85
  v_perm_b32 v5, v92, v88, s86
  v_dot2_f32_bf16 v16, v4, v27, v16
  v_dot2_f32_bf16 v17, v5, v27, v17
  v_perm_b32 v6, v93, v89, s85
  v_perm_b32 v7, v93, v89, s86
  v_dot2_f32_bf16 v18, v6, v27, v18
  v_dot2_f32_bf16 v19, v7, v27, v19
  v_perm_b32 v4, v94, v90, s85
  v_perm_b32 v5, v94, v90, s86
  v_dot2_f32_bf16 v20, v4, v27, v20
  v_dot2_f32_bf16 v21, v5, v27, v21
  v_perm_b32 v6, v95, v91, s85
  v_perm_b32 v7, v95, v91, s86
  v_dot2_f32_bf16 v22, v6, v27, v22
  v_dot2_f32_bf16 v23, v7, v27, v23
  v_perm_b32 v4, v99, v98, s85
  v_perm_b32 v5, v99, v98, s86
  v_dot2_f32_bf16 v24, v4, v27, v24
  v_dot2_f32_bf16 v25, v5, v27, v25
  v_perm_b32 v4, v68, v64, s85
  v_perm_b32 v5, v68, v64, s86
  v_dot2_f32_bf16 v16, v4, v28, v16
  v_dot2_f32_bf16 v17, v5, v28, v17
  v_perm_b32 v6, v69, v65, s85
  v_perm_b32 v7, v69, v65, s86
  v_dot2_f32_bf16 v18, v6, v28, v18
  v_dot2_f32_bf16 v19, v7, v28, v19
  v_perm_b32 v4, v70, v66, s85
  v_perm_b32 v5, v70, v66, s86
  v_dot2_f32_bf16 v20, v4, v28, v20
  v_dot2_f32_bf16 v21, v5, v28, v21
  v_perm_b32 v6, v71, v67, s85
  v_perm_b32 v7, v71, v67, s86
  v_dot2_f32_bf16 v22, v6, v28, v22
  v_dot2_f32_bf16 v23, v7, v28, v23
  v_perm_b32 v4, v77, v76, s85
  v_perm_b32 v5, v77, v76, s86
  v_dot2_f32_bf16 v24, v4, v28, v24
  v_dot2_f32_bf16 v25, v5, v28, v25
  v_perm_b32 v4, v104, v72, s85
  v_perm_b32 v5, v104, v72, s86
  v_dot2_f32_bf16 v16, v4, v29, v16
  v_dot2_f32_bf16 v17, v5, v29, v17
  v_perm_b32 v6, v105, v73, s85
  v_perm_b32 v7, v105, v73, s86
  v_dot2_f32_bf16 v18, v6, v29, v18
  v_dot2_f32_bf16 v19, v7, v29, v19
  v_perm_b32 v4, v106, v74, s85
  v_perm_b32 v5, v106, v74, s86
  v_dot2_f32_bf16 v20, v4, v29, v20
  v_dot2_f32_bf16 v21, v5, v29, v21
  v_perm_b32 v6, v107, v75, s85
  v_perm_b32 v7, v107, v75, s86
  v_dot2_f32_bf16 v22, v6, v29, v22
  v_dot2_f32_bf16 v23, v7, v29, v23
  v_perm_b32 v4, v120, v78, s85
  v_perm_b32 v5, v120, v78, s86
  v_dot2_f32_bf16 v24, v4, v29, v24
  v_dot2_f32_bf16 v25, v5, v29, v25
  v_perm_b32 v4, v112, v108, s85
  v_perm_b32 v5, v112, v108, s86
  v_dot2_f32_bf16 v16, v4, v30, v16
  v_dot2_f32_bf16 v17, v5, v30, v17
  v_perm_b32 v6, v113, v109, s85
  v_perm_b32 v7, v113, v109, s86
  v_dot2_f32_bf16 v18, v6, v30, v18
  v_dot2_f32_bf16 v19, v7, v30, v19
  v_perm_b32 v4, v114, v110, s85
  v_perm_b32 v5, v114, v110, s86
  v_dot2_f32_bf16 v20, v4, v30, v20
  v_dot2_f32_bf16 v21, v5, v30, v21
  v_perm_b32 v6, v115, v111, s85
  v_perm_b32 v7, v115, v111, s86
  v_dot2_f32_bf16 v22, v6, v30, v22
  v_dot2_f32_bf16 v23, v7, v30, v23
  v_perm_b32 v4, v122, v121, s85
  v_perm_b32 v5, v122, v121, s86
  v_dot2_f32_bf16 v24, v4, v30, v24
  v_dot2_f32_bf16 v25, v5, v30, v25
  v_perm_b32 v4, v32, v116, s85
  v_perm_b32 v5, v32, v116, s86
  v_dot2_f32_bf16 v16, v4, v31, v16
  v_dot2_f32_bf16 v17, v5, v31, v17
  v_perm_b32 v6, v33, v117, s85
  v_perm_b32 v7, v33, v117, s86
  v_dot2_f32_bf16 v18, v6, v31, v18
  v_dot2_f32_bf16 v19, v7, v31, v19
  v_perm_b32 v4, v34, v118, s85
  v_perm_b32 v5, v34, v118, s86
  v_dot2_f32_bf16 v20, v4, v31, v20
  v_dot2_f32_bf16 v21, v5, v31, v21
  v_perm_b32 v6, v35, v119, s85
  v_perm_b32 v7, v35, v119, s86
  v_dot2_f32_bf16 v22, v6, v31, v22
  v_dot2_f32_bf16 v23, v7, v31, v23
  v_perm_b32 v4, v48, v123, s85
  v_perm_b32 v5, v48, v123, s86
  v_dot2_f32_bf16 v24, v4, v31, v24
  v_dot2_f32_bf16 v25, v5, v31, v25
  s_mul_i32 s63, s60, 5120
  v_lshlrev_b32 v1, 5, v0
  v_add_u32 v1, s63, v1
  v_lshlrev_b32 v2, 3, v0
  v_add_u32 v2, s63, v2
  s_mul_i32 s63, s60, 12
  v_mov_b32 v3, s63
  ds_read_b32 v26, v3 offset:35328
  ds_read_b32 v27, v3 offset:35332
  ds_read_b32 v28, v3 offset:35336
  ds_write_b128 v1, v[16:19] offset:36864
  ds_write_b128 v1, v[20:23] offset:36880
  ds_write_b64 v2, v[24:25] offset:38912
  s_waitcnt vmcnt(0)
  s_waitcnt lgkmcnt(0)
  v_lshlrev_b32 v4, 16, v36
  v_and_b32 v5, 0xffff0000, v36
  v_mul_f32 v80, v4, v26
  v_mul_f32 v81, v5, v26
  v_lshlrev_b32 v4, 16, v37
  v_and_b32 v5, 0xffff0000, v37
  v_mul_f32 v82, v4, v26
  v_mul_f32 v83, v5, v26
  v_lshlrev_b32 v4, 16, v38
  v_and_b32 v5, 0xffff0000, v38
  v_mul_f32 v84, v4, v26
  v_mul_f32 v85, v5, v26
  v_lshlrev_b32 v4, 16, v39
  v_and_b32 v5, 0xffff0000, v39
  v_mul_f32 v86, v4, v26
  v_mul_f32 v87, v5, v26
  v_lshlrev_b32 v4, 16, v49
  v_and_b32 v5, 0xffff0000, v49
  v_mul_f32 v88, v4, v26
  v_mul_f32 v89, v5, v26
  v_lshlrev_b32 v4, 16, v40
  v_and_b32 v5, 0xffff0000, v40
  v_fmac_f32 v80, v4, v27
  v_fmac_f32 v81, v5, v27
  v_lshlrev_b32 v4, 16, v41
  v_and_b32 v5, 0xffff0000, v41
  v_fmac_f32 v82, v4, v27
  v_fmac_f32 v83, v5, v27
  v_lshlrev_b32 v4, 16, v42
  v_and_b32 v5, 0xffff0000, v42
  v_fmac_f32 v84, v4, v27
  v_fmac_f32 v85, v5, v27
  v_lshlrev_b32 v4, 16, v43
  v_and_b32 v5, 0xffff0000, v43
  v_fmac_f32 v86, v4, v27
  v_fmac_f32 v87, v5, v27
  v_lshlrev_b32 v4, 16, v50
  v_and_b32 v5, 0xffff0000, v50
  v_fmac_f32 v88, v4, v27
  v_fmac_f32 v89, v5, v27
  v_lshlrev_b32 v4, 16, v44
  v_and_b32 v5, 0xffff0000, v44
  v_fmac_f32 v80, v4, v28
  v_fmac_f32 v81, v5, v28
  v_lshlrev_b32 v4, 16, v45
  v_and_b32 v5, 0xffff0000, v45
  v_fmac_f32 v82, v4, v28
  v_fmac_f32 v83, v5, v28
  v_lshlrev_b32 v4, 16, v46
  v_and_b32 v5, 0xffff0000, v46
  v_fmac_f32 v84, v4, v28
  v_fmac_f32 v85, v5, v28
  v_lshlrev_b32 v4, 16, v47
  v_and_b32 v5, 0xffff0000, v47
  v_fmac_f32 v86, v4, v28
  v_fmac_f32 v87, v5, v28
  v_lshlrev_b32 v4, 16, v51
  v_and_b32 v5, 0xffff0000, v51
  v_fmac_f32 v88, v4, v28
  v_fmac_f32 v89, v5, v28
  ds_write_b128 v1, v[80:83] offset:39424
  ds_write_b128 v1, v[84:87] offset:39440
  ds_write_b64 v2, v[88:89] offset:41472
  s_waitcnt lgkmcnt(0)
  s_barrier
  s_cmp_ge_u32 s60, 10
  s_cbranch_scc1 L_a_end
  s_lshl_b32 s63, s60, 8
  v_lshlrev_b32 v1, 2, v0
  v_add_u32 v1, s63, v1
  v_add_u32 v2, 36864, v1
  v_add_u32 v3, 77824, v1
  ds_read_b32 v32, v2 offset:0
  ds_read_b32 v48, v2 offset:2560
  ds_read_b32 v33, v2 offset:5120
  ds_read_b32 v49, v2 offset:7680
  ds_read_b32 v34, v2 offset:10240
  ds_read_b32 v50, v2 offset:12800
  ds_read_b32 v35, v2 offset:15360
  ds_read_b32 v51, v2 offset:17920
  ds_read_b32 v36, v2 offset:20480
  ds_read_b32 v52, v2 offset:23040
  ds_read_b32 v37, v2 offset:25600
  ds_read_b32 v53, v2 offset:28160
  ds_read_b32 v38, v2 offset:30720
  ds_read_b32 v54, v2 offset:33280
  ds_read_b32 v39, v2 offset:35840
  ds_read_b32 v55, v2 offset:38400
  ds_read_b32 v40, v3 offset:0
  ds_read_b32 v56, v3 offset:2560
  ds_read_b32 v41, v3 offset:5120
  ds_read_b32 v57, v3 offset:7680
  ds_read_b32 v42, v3 offset:10240
  ds_read_b32 v58, v3 offset:12800
  ds_read_b32 v43, v3 offset:15360
  ds_read_b32 v59, v3 offset:17920
  ds_read_b32 v44, v3 offset:20480
  ds_read_b32 v60, v3 offset:23040
  ds_read_b32 v45, v3 offset:25600
  ds_read_b32 v61, v3 offset:28160
  ds_read_b32 v46, v3 offset:30720
  ds_read_b32 v62, v3 offset:33280
  ds_read_b32 v47, v3 offset:35840
  ds_read_b32 v63, v3 offset:38400
  s_waitcnt lgkmcnt(0)
  v_add_f32 v32, v32, v33
  v_add_f32 v48, v48, v49
  v_add_f32 v32, v32, v34
  v_add_f32 v48, v48, v50
  v_add_f32 v32, v32, v35
  v_add_f32 v48, v48, v51
  v_add_f32 v32, v32, v36
  v_add_f32 v48, v48, v52
  v_add_f32 v32, v32, v37
  v_add_f32 v48, v48, v53
  v_add_f32 v32, v32, v38
  v_add_f32 v48, v48, v54
  v_add_f32 v32, v32, v39
  v_add_f32 v48, v48, v55
  v_add_f32 v32, v32, v40
  v_add_f32 v48, v48, v56
  v_add_f32 v32, v32, v41
  v_add_f32 v48, v48, v57
  v_add_f32 v32, v32, v42
  v_add_f32 v48, v48, v58
  v_add_f32 v32, v32, v43
  v_add_f32 v48, v48, v59
  v_add_f32 v32, v32, v44
  v_add_f32 v48, v48, v60
  v_add_f32 v32, v32, v45
  v_add_f32 v48, v48, v61
  v_add_f32 v32, v32, v46
  v_add_f32 v48, v48, v62
  v_add_f32 v32, v32, v47
  v_add_f32 v48, v48, v63
  s_mul_i32 s63, s2, 2560
  v_add_u32 v1, s63, v1
  buffer_store_dword v32, v1, s[52:55], 0 offen offset:0
  v_add_u32 v2, 655360, v1
  buffer_store_dword v48, v2, s[52:55], 0 offen
  s_waitcnt vmcnt(0)
L_a_end:
  s_endpgm
.globl mixb_kernel
.p2align 8
.type mixb_kernel,@function
mixb_kernel:
  s_cmp_ge_u32 s2, 20
  s_cbranch_scc1 L_b_end
  s_load_dwordx2 s[4:5], s[0:1], 0
  s_load_dwordx2 s[6:7], s[0:1], 72
  s_load_dwordx2 s[8:9], s[0:1], 80
  s_load_dwordx2 s[10:11], s[0:1], 96
  v_lshrrev_b32 v1, 6, v0
  v_and_b32 v0, 63, v0
  v_readfirstlane_b32 s12, v1
  s_lshl_b32 s13, s2, 2
  s_add_u32 s12, s12, s13
  s_mul_i32 s13, s12, 205
  s_lshr_b32 s13, s13, 11
  s_mul_i32 s14, s13, 10
  s_sub_u32 s14, s12, s14
  s_waitcnt lgkmcnt(0)
  s_mov_b32 s16, s4
  s_and_b32 s17, s5, 0xffff
  s_mov_b32 s18, 10240
  s_mov_b32 s19, 0x00020000
  s_mov_b32 s20, s6
  s_and_b32 s21, s7, 0xffff
  s_mov_b32 s22, 1280
  s_mov_b32 s23, 0x00020000
  s_mov_b32 s24, s8
  s_and_b32 s25, s9, 0xffff
  s_mov_b32 s26, 10240
  s_mov_b32 s27, 0x00020000
  s_mov_b32 s28, s10
  s_and_b32 s29, s11, 0xffff
  s_mov_b32 s30, 8388608
  s_mov_b32 s31, 0x00020000
  s_mul_i32 s15, s13, 81920
  s_lshl_b32 s32, s14, 8
  s_add_u32 s15, s15, s32
  v_lshlrev_b32 v1, 2, v0
  v_add_u32 v1, s15, v1
  v_add_u32 v2, 655360, v1
  s_mov_b32 s33, 0
  buffer_load_dword v16, v1, s[28:31], s33 offen
  buffer_load_dword v48, v2, s[28:31], s33 offen
  s_add_u32 s33, s33, 2560
  buffer_load_dword v17, v1, s[28:31], s33 offen
  buffer_load_dword v49, v2, s[28:31], s33 offen
  s_add_u32 s33, s33, 2560
  buffer_load_dword v18, v1, s[28:31], s33 offen
  buffer_load_dword v50, v2, s[28:31], s33 offen
  s_add_u32 s33, s33, 2560
  buffer_load_dword v19, v1, s[28:31], s33 offen
  buffer_load_dword v51, v2, s[28:31], s33 offen
  s_add_u32 s33, s33, 2560
  buffer_load_dword v20, v1, s[28:31], s33 offen
  buffer_load_dword v52, v2, s[28:31], s33 offen
  s_add_u32 s33, s33, 2560
  buffer_load_dword v21, v1, s[28:31], s33 offen
  buffer_load_dword v53, v2, s[28:31], s33 offen
  s_add_u32 s33, s33, 2560
  buffer_load_dword v22, v1, s[28:31], s33 offen
  buffer_load_dword v54, v2, s[28:31], s33 offen
  s_add_u32 s33, s33, 2560
  buffer_load_dword v23, v1, s[28:31], s33 offen
  buffer_load_dword v55, v2, s[28:31], s33 offen
  s_add_u32 s33, s33, 2560
  buffer_load_dword v24, v1, s[28:31], s33 offen
  buffer_load_dword v56, v2, s[28:31], s33 offen
  s_add_u32 s33, s33, 2560
  buffer_load_dword v25, v1, s[28:31], s33 offen
  buffer_load_dword v57, v2, s[28:31], s33 offen
  s_add_u32 s33, s33, 2560
  buffer_load_dword v26, v1, s[28:31], s33 offen
  buffer_load_dword v58, v2, s[28:31], s33 offen
  s_add_u32 s33, s33, 2560
  buffer_load_dword v27, v1, s[28:31], s33 offen
  buffer_load_dword v59, v2, s[28:31], s33 offen
  s_add_u32 s33, s33, 2560
  buffer_load_dword v28, v1, s[28:31], s33 offen
  buffer_load_dword v60, v2, s[28:31], s33 offen
  s_add_u32 s33, s33, 2560
  buffer_load_dword v29, v1, s[28:31], s33 offen
  buffer_load_dword v61, v2, s[28:31], s33 offen
  s_add_u32 s33, s33, 2560
  buffer_load_dword v30, v1, s[28:31], s33 offen
  buffer_load_dword v62, v2, s[28:31], s33 offen
  s_add_u32 s33, s33, 2560
  buffer_load_dword v31, v1, s[28:31], s33 offen
  buffer_load_dword v63, v2, s[28:31], s33 offen
  s_add_u32 s33, s33, 2560
  buffer_load_dword v32, v1, s[28:31], s33 offen
  buffer_load_dword v64, v2, s[28:31], s33 offen
  s_add_u32 s33, s33, 2560
  buffer_load_dword v33, v1, s[28:31], s33 offen
  buffer_load_dword v65, v2, s[28:31], s33 offen
  s_add_u32 s33, s33, 2560
  buffer_load_dword v34, v1, s[28:31], s33 offen
  buffer_load_dword v66, v2, s[28:31], s33 offen
  s_add_u32 s33, s33, 2560
  buffer_load_dword v35, v1, s[28:31], s33 offen
  buffer_load_dword v67, v2, s[28:31], s33 offen
  s_add_u32 s33, s33, 2560
  buffer_load_dword v36, v1, s[28:31], s33 offen
  buffer_load_dword v68, v2, s[28:31], s33 offen
  s_add_u32 s33, s33, 2560
  buffer_load_dword v37, v1, s[28:31], s33 offen
  buffer_load_dword v69, v2, s[28:31], s33 offen
  s_add_u32 s33, s33, 2560
  buffer_load_dword v38, v1, s[28:31], s33 offen
  buffer_load_dword v70, v2, s[28:31], s33 offen
  s_add_u32 s33, s33, 2560
  buffer_load_dword v39, v1, s[28:31], s33 offen
  buffer_load_dword v71, v2, s[28:31], s33 offen
  s_add_u32 s33, s33, 2560
  buffer_load_dword v40, v1, s[28:31], s33 offen
  buffer_load_dword v72, v2, s[28:31], s33 offen
  s_add_u32 s33, s33, 2560
  buffer_load_dword v41, v1, s[28:31], s33 offen
  buffer_load_dword v73, v2, s[28:31], s33 offen
  s_add_u32 s33, s33, 2560
  buffer_load_dword v42, v1, s[28:31], s33 offen
  buffer_load_dword v74, v2, s[28:31], s33 offen
  s_add_u32 s33, s33, 2560
  buffer_load_dword v43, v1, s[28:31], s33 offen
  buffer_load_dword v75, v2, s[28:31], s33 offen
  s_add_u32 s33, s33, 2560
  buffer_load_dword v44, v1, s[28:31], s33 offen
  buffer_load_dword v76, v2, s[28:31], s33 offen
  s_add_u32 s33, s33, 2560
  buffer_load_dword v45, v1, s[28:31], s33 offen
  buffer_load_dword v77, v2, s[28:31], s33 offen
  s_add_u32 s33, s33, 2560
  buffer_load_dword v46, v1, s[28:31], s33 offen
  buffer_load_dword v78, v2, s[28:31], s33 offen
  s_add_u32 s33, s33, 2560
  buffer_load_dword v47, v1, s[28:31], s33 offen
  buffer_load_dword v79, v2, s[28:31], s33 offen
  v_mul_u32_u24 v3, 20, v0
  s_mul_i32 s34, s13, 1280
  v_add_u32 v4, s34, v3
  buffer_load_dword v80, v4, s[16:19], 0 offen offset:0
  buffer_load_dword v86, v3, s[20:23], 0 offen offset:0
  buffer_load_dword v81, v4, s[16:19], 0 offen offset:4
  buffer_load_dword v87, v3, s[20:23], 0 offen offset:4
  buffer_load_dword v82, v4, s[16:19], 0 offen offset:8
  buffer_load_dword v88, v3, s[20:23], 0 offen offset:8
  buffer_load_dword v83, v4, s[16:19], 0 offen offset:12
  buffer_load_dword v89, v3, s[20:23], 0 offen offset:12
  buffer_load_dword v84, v4, s[16:19], 0 offen offset:16
  buffer_load_dword v90, v3, s[20:23], 0 offen offset:16
  v_mov_b32 v5, 0
  s_waitcnt vmcnt(0)
  v_lshlrev_b32 v6, 16, v80
  v_lshlrev_b32 v7, 16, v86
  v_mul_f32 v6, v6, v7
  v_cvt_pk_bf16_f32 v6, v6, v6
  v_lshlrev_b32 v6, 16, v6
  v_add_f32 v5, v5, v6
  v_and_b32 v6, 0xffff0000, v80
  v_and_b32 v7, 0xffff0000, v86
  v_mul_f32 v6, v6, v7
  v_cvt_pk_bf16_f32 v6, v6, v6
  v_lshlrev_b32 v6, 16, v6
  v_add_f32 v5, v5, v6
  v_lshlrev_b32 v6, 16, v81
  v_lshlrev_b32 v7, 16, v87
  v_mul_f32 v6, v6, v7
  v_cvt_pk_bf16_f32 v6, v6, v6
  v_lshlrev_b32 v6, 16, v6
  v_add_f32 v5, v5, v6
  v_and_b32 v6, 0xffff0000, v81
  v_and_b32 v7, 0xffff0000, v87
  v_mul_f32 v6, v6, v7
  v_cvt_pk_bf16_f32 v6, v6, v6
  v_lshlrev_b32 v6, 16, v6
  v_add_f32 v5, v5, v6
  v_lshlrev_b32 v6, 16, v82
  v_lshlrev_b32 v7, 16, v88
  v_mul_f32 v6, v6, v7
  v_cvt_pk_bf16_f32 v6, v6, v6
  v_lshlrev_b32 v6, 16, v6
  v_add_f32 v5, v5, v6
  v_and_b32 v6, 0xffff0000, v82
  v_and_b32 v7, 0xffff0000, v88
  v_mul_f32 v6, v6, v7
  v_cvt_pk_bf16_f32 v6, v6, v6
  v_lshlrev_b32 v6, 16, v6
  v_add_f32 v5, v5, v6
  v_lshlrev_b32 v6, 16, v83
  v_lshlrev_b32 v7, 16, v89
  v_mul_f32 v6, v6, v7
  v_cvt_pk_bf16_f32 v6, v6, v6
  v_lshlrev_b32 v6, 16, v6
  v_add_f32 v5, v5, v6
  v_and_b32 v6, 0xffff0000, v83
  v_and_b32 v7, 0xffff0000, v89
  v_mul_f32 v6, v6, v7
  v_cvt_pk_bf16_f32 v6, v6, v6
  v_lshlrev_b32 v6, 16, v6
  v_add_f32 v5, v5, v6
  v_lshlrev_b32 v6, 16, v84
  v_lshlrev_b32 v7, 16, v90
  v_mul_f32 v6, v6, v7
  v_cvt_pk_bf16_f32 v6, v6, v6
  v_lshlrev_b32 v6, 16, v6
  v_add_f32 v5, v5, v6
  v_and_b32 v6, 0xffff0000, v84
  v_and_b32 v7, 0xffff0000, v90
  v_mul_f32 v6, v6, v7
  v_cvt_pk_bf16_f32 v6, v6, v6
  v_lshlrev_b32 v6, 16, v6
  v_add_f32 v5, v5, v6
  s_nop 1
  v_add_f32_dpp v5, v5, v5 row_ror:8 row_mask:0xf bank_mask:0xf
  s_nop 1
  v_add_f32_dpp v5, v5, v5 row_ror:4 row_mask:0xf bank_mask:0xf
  s_nop 1
  v_add_f32_dpp v5, v5, v5 row_ror:2 row_mask:0xf bank_mask:0xf
  s_nop 1
  v_add_f32_dpp v5, v5, v5 row_ror:1 row_mask:0xf bank_mask:0xf
  s_nop 1
  v_readlane_b32 s36, v5, 0
  v_readlane_b32 s37, v5, 16
  v_readlane_b32 s38, v5, 32
  v_readlane_b32 s39, v5, 48
  s_nop 1
  v_mov_b32 v5, s36
  v_add_f32 v5, s37, v5
  v_add_f32 v5, s38, v5
  v_add_f32 v5, s39, v5
  v_cvt_pk_bf16_f32 v5, v5, v5
  v_lshlrev_b32 v5, 16, v5
  v_mul_f32 v5, 0xbfb8aa3b, v5
  v_exp_f32 v5, v5
  s_nop 0
  v_add_f32 v5, 1.0, v5
  v_rcp_f32 v5, v5
  s_nop 0
  v_cvt_pk_bf16_f32 v5, v5, v5
  v_lshlrev_b32 v5, 16, v5
  v_sub_f32 v6, 1.0, v5
  v_cvt_pk_bf16_f32 v6, v6, v6
  v_lshlrev_b32 v6, 16, v6
  s_waitcnt vmcnt(0)
  v_add_f32 v16, v16, v17
  v_add_f32 v48, v48, v49
  v_add_f32 v16, v16, v18
  v_add_f32 v48, v48, v50
  v_add_f32 v16, v16, v19
  v_add_f32 v48, v48, v51
  v_add_f32 v16, v16, v20
  v_add_f32 v48, v48, v52
  v_add_f32 v16, v16, v21
  v_add_f32 v48, v48, v53
  v_add_f32 v16, v16, v22
  v_add_f32 v48, v48, v54
  v_add_f32 v16, v16, v23
  v_add_f32 v48, v48, v55
  v_add_f32 v16, v16, v24
  v_add_f32 v48, v48, v56
  v_add_f32 v16, v16, v25
  v_add_f32 v48, v48, v57
  v_add_f32 v16, v16, v26
  v_add_f32 v48, v48, v58
  v_add_f32 v16, v16, v27
  v_add_f32 v48, v48, v59
  v_add_f32 v16, v16, v28
  v_add_f32 v48, v48, v60
  v_add_f32 v16, v16, v29
  v_add_f32 v48, v48, v61
  v_add_f32 v16, v16, v30
  v_add_f32 v48, v48, v62
  v_add_f32 v16, v16, v31
  v_add_f32 v48, v48, v63
  v_add_f32 v16, v16, v32
  v_add_f32 v48, v48, v64
  v_add_f32 v16, v16, v33
  v_add_f32 v48, v48, v65
  v_add_f32 v16, v16, v34
  v_add_f32 v48, v48, v66
  v_add_f32 v16, v16, v35
  v_add_f32 v48, v48, v67
  v_add_f32 v16, v16, v36
  v_add_f32 v48, v48, v68
  v_add_f32 v16, v16, v37
  v_add_f32 v48, v48, v69
  v_add_f32 v16, v16, v38
  v_add_f32 v48, v48, v70
  v_add_f32 v16, v16, v39
  v_add_f32 v48, v48, v71
  v_add_f32 v16, v16, v40
  v_add_f32 v48, v48, v72
  v_add_f32 v16, v16, v41
  v_add_f32 v48, v48, v73
  v_add_f32 v16, v16, v42
  v_add_f32 v48, v48, v74
  v_add_f32 v16, v16, v43
  v_add_f32 v48, v48, v75
  v_add_f32 v16, v16, v44
  v_add_f32 v48, v48, v76
  v_add_f32 v16, v16, v45
  v_add_f32 v48, v48, v77
  v_add_f32 v16, v16, v46
  v_add_f32 v48, v48, v78
  v_add_f32 v16, v16, v47
  v_add_f32 v48, v48, v79
  v_cvt_pk_bf16_f32 v16, v16, v16
  v_lshlrev_b32 v16, 16, v16
  v_cvt_pk_bf16_f32 v48, v48, v48
  v_lshlrev_b32 v48, 16, v48
  v_mul_f32 v16, v5, v16
  v_cvt_pk_bf16_f32 v16, v16, v16
  v_lshlrev_b32 v16, 16, v16
  v_mul_f32 v48, v6, v48
  v_cvt_pk_bf16_f32 v48, v48, v48
  v_lshlrev_b32 v48, 16, v48
  v_add_f32 v16, v16, v48
  v_cvt_pk_bf16_f32 v16, v16, v16
  s_lshl_b32 s32, s14, 7
  s_add_u32 s34, s34, s32
  v_lshlrev_b32 v1, 1, v0
  v_add_u32 v1, s34, v1
  buffer_store_short v16, v1, s[24:27], 0 offen
  s_waitcnt vmcnt(0)
L_b_end:
  s_endpgm
.section .rodata,"a"
.p2align 6
.amdhsa_kernel gated_mix__sliding_block_cached__geglu_ffn__decode_kernel
  .amdhsa_next_free_vgpr 128
  .amdhsa_next_free_sgpr 100
  .amdhsa_accum_offset 128
  .amdhsa_group_segment_fixed_size 0
  .amdhsa_kernarg_size 104
  .amdhsa_user_sgpr_count 2
  .amdhsa_user_sgpr_kernarg_segment_ptr 1
  .amdhsa_system_sgpr_workgroup_id_x 1
.end_amdhsa_kernel
.p2align 6
.amdhsa_kernel mixb_kernel
  .amdhsa_next_free_vgpr 96
  .amdhsa_next_free_sgpr 48
  .amdhsa_accum_offset 96
  .amdhsa_group_segment_fixed_size 0
  .amdhsa_kernarg_size 104
  .amdhsa_user_sgpr_count 2
  .amdhsa_user_sgpr_kernarg_segment_ptr 1
  .amdhsa_system_sgpr_workgroup_id_x 1
.end_amdhsa_kernel
```
